```python
import torch

def _softmax(x, axis=-1):
    return torch.softmax(x, dim=axis)

def _gelu(x):
    return torch.nn.functional.gelu(x, approximate='tanh')

def _silu(x):
    return torch.nn.functional.silu(x)

def _sigmoid(x):
    return torch.sigmoid(x)

def _layernorm(x, axis=-1, eps=1e-05):
    m = x.mean(dim=axis, keepdim=True)
    v = x.var(dim=axis, keepdim=True, unbiased=False)
    return (x - m) / torch.sqrt(v + eps)

def _scatter_add(tgt, idx, src, axis=0):
    return tgt.clone().index_add_(axis, idx, src)

def _segment_sum(src, seg, n):
    out = torch.zeros((n,) + src.shape[1:], dtype=src.dtype)
    return out.index_add_(0, seg, src)

def _pad(x, pw):
    flat = tuple((v for pair in reversed(pw) for v in pair))
    return torch.nn.functional.pad(x, flat)
kernel_name = 'adaLN_cond__gqa_block_cached__glu_gated_bilinear__decode'

def setup_inputs():

    _w = lambda a: (lambda t: t.to(torch.bfloat16) if t.is_floating_point() else t)(torch.as_tensor(a))

    def _A_setup():
        B, Sq, D = (1, 1, 640)
        Hq, Hkv, Sk, Dh = (32, 32, 4096, 192)
        assert Hq % Hkv == 0, (Hq, Hkv)
        return {'x': _w((lambda *s: torch.randn(*s, dtype=torch.bfloat16) * 0.1)(B, Sq, D)), 'k_cache': _w((lambda *s: torch.randn(*s, dtype=torch.bfloat16) * 0.8)(B, Hkv, Sk, Dh)), 'v_cache': _w((lambda *s: torch.randn(*s, dtype=torch.bfloat16) * 3.2)(B, Hkv, Sk, Dh)), 'wq': _w((lambda *s: torch.randn(*s, dtype=torch.bfloat16) * 0.8)(D, Hq * Dh) * D ** (-0.5)), 'wo': _w((lambda *s: torch.randn(*s, dtype=torch.bfloat16) * 3.2)(Hq * Dh, D) * (Hq * Dh) ** (-0.5))}
    _A_in = _A_setup()

    def _B_setup():
        B, S, D, F = (1, 1, 640, 1536)
        return {'x': _w((lambda *s: torch.randn(*s, dtype=torch.bfloat16) * 0.1)(B, S, D)), 'w_gate': _w((lambda *s: torch.randn(*s, dtype=torch.bfloat16) * 3.2)(D, F) * D ** (-0.5)), 'w_up': _w((lambda *s: torch.randn(*s, dtype=torch.bfloat16) * 3.2)(D, F) * D ** (-0.5)), 'w_down': _w((lambda *s: torch.randn(*s, dtype=torch.bfloat16) * 3.2)(F, D) * F ** (-0.5))}
    _B_in = _B_setup()
    return {'A_x': _A_in['x'], 'A_k_cache': _A_in['k_cache'], 'A_v_cache': _A_in['v_cache'], 'A_wq': _A_in['wq'], 'A_wo': _A_in['wo'], 'B_x': _B_in['x'], 'B_w_gate': _B_in['w_gate'], 'B_w_up': _B_in['w_up'], 'B_w_down': _B_in['w_down'], 'c': _w((lambda *s: torch.randn(*s, dtype=torch.bfloat16) * 0.4)(1, 640) * 8.0), 'w_mod': _w((lambda *s: torch.randn(*s, dtype=torch.bfloat16) * 0.4)(640, 6 * 640) * 640 ** (-0.5) * 8.0)}

def reference(A_x, A_k_cache, A_v_cache, A_wq, A_wo, B_x, B_w_gate, B_w_up, B_w_down, c, w_mod):

    def _A_ref(x, k_cache, v_cache, wq, wo):
        B, Sq, D = x.shape
        Hq, Dh = (32, 192)
        Hkv = k_cache.shape[1]
        rep = Hq // Hkv
        q = (lambda x, *d: x.permute(*d))((x @ wq).reshape(B, Sq, Hq, Dh), 0, 2, 1, 3)
        k = (lambda x, n, axis: torch.repeat_interleave(x, n, dim=axis))(k_cache, rep, axis=1)
        v = (lambda x, n, axis: torch.repeat_interleave(x, n, dim=axis))(v_cache, rep, axis=1)
        scores = torch.einsum('bhqd,bhkd->bhqk', q, k) * Dh ** (-0.5)
        p = _softmax(scores, axis=-1)
        o = torch.einsum('bhqk,bhkd->bhqd', p, v)
        return (lambda x, *d: x.permute(*d))(o, 0, 2, 1, 3).reshape(B, Sq, Hq * Dh) @ wo

    def _B_ref(x, w_gate, w_up, w_down):
        g = torch.einsum('bsd,df->bsf', x, w_gate)
        u = torch.einsum('bsd,df->bsf', x, w_up)
        h = g * u
        return torch.einsum('bsf,fd->bsd', h, w_down)
    x = A_x
    mod = (_silu(c) @ w_mod).reshape(c.shape[0], 6, 1, -1)
    sa, ca, ga, sb, cb, gb = (mod[:, 0].clone(), mod[:, 1].clone(), mod[:, 2].clone(), mod[:, 3].clone(), mod[:, 4].clone(), mod[:, 5].clone())
    h = _layernorm(x, axis=-1) * (1 + ca) + sa
    x = x + ga * _A_ref(h, A_k_cache, A_v_cache, A_wq, A_wo)
    h = _layernorm(x, axis=-1) * (1 + cb) + sb
    x = x + gb * _B_ref(h, B_w_gate, B_w_up, B_w_down)
    return x
```

```asm
; @launch grid=(256,1,1) block=(768,1,1) lds=73728
.amdgcn_target "amdgcn-amd-amdhsa--gfx950"
.text
.globl adaLN_cond__gqa_block_cached__glu_gated_bilinear__decode_kernel
.p2align 8
.type adaLN_cond__gqa_block_cached__glu_gated_bilinear__decode_kernel,@function
adaLN_cond__gqa_block_cached__glu_gated_bilinear__decode_kernel:
    s_cmp_ge_u32 s2, 256
    s_cbranch_scc1 L_end
    s_load_dwordx16 s[48:63], s[0:1], 0
    s_load_dwordx8 s[64:71], s[0:1], 64
    s_load_dwordx4 s[72:75], s[0:1], 96
    v_lshrrev_b32 v1, 6, v0
    v_and_b32 v0, 63, v0
    v_readfirstlane_b32 s3, v1
    s_and_b32 s4, s2, 7
    s_lshr_b32 s5, s2, 3
    s_lshl_b32 s6, s4, 5
    s_add_u32 s6, s6, s5
    s_lshr_b32 s7, s6, 3
    s_and_b32 s46, s6, 7
    s_mov_b32 s94, 0x3fb8aa3b
    s_mov_b32 s45, 0
    s_waitcnt lgkmcnt(0)

    s_mov_b32 s16, s74
    s_mov_b32 s17, s75
    s_mov_b32 s18, 268435456
    s_mov_b32 s19, 0x20000
    s_cmp_eq_u32 s3, 8
    s_cbranch_scc1 L_A0
    s_cmp_eq_u32 s3, 9
    s_cbranch_scc1 L_A1
    s_cmp_eq_u32 s3, 10
    s_cbranch_scc1 L_A2
    s_cmp_eq_u32 s3, 11
    s_cbranch_scc1 L_A3

    s_mov_b32 s8, s50
    s_mov_b32 s9, s51
    s_mov_b32 s10, 50331648
    s_mov_b32 s11, 0x20000
    s_mov_b32 s12, s52
    s_mov_b32 s13, s53
    s_mov_b32 s14, 50331648
    s_mov_b32 s15, 0x20000
    s_cmp_lt_u32 s3, 4
    s_cbranch_scc1 L_S_np
    s_setprio 1
L_S_np:
    s_mul_i32 s20, s6, 196608
    s_mul_i32 s21, s3, 24576
    s_add_u32 s20, s20, s21
    v_and_b32 v4, 7, v0
    v_mul_u32_u24 v1, 384, v4
    v_bfe_u32 v4, v0, 3, 1
    v_lshl_add_u32 v1, v4, 6, v1
    v_lshrrev_b32 v4, 4, v0
    v_lshl_add_u32 v1, v4, 4, v1

    s_add_u32 s21, s20, 0
    buffer_load_dwordx4 v[28:31], v1, s[8:11], s21 offen offset:0 nt
    buffer_load_dwordx4 v[32:35], v1, s[8:11], s21 offen offset:128 nt
    buffer_load_dwordx4 v[36:39], v1, s[8:11], s21 offen offset:256 nt
    v_lshrrev_b32 v4, 4, v0
    v_and_b32 v5, 15, v0
    v_mul_u32_u24 v2, 384, v4
    v_lshl_add_u32 v2, v5, 4, v2
    v_bfe_u32 v5, v0, 3, 1
    v_lshl_add_u32 v3, v5, 2, v4
    v_mul_u32_u24 v3, 384, v3
    v_and_b32 v5, 7, v0
    v_lshl_add_u32 v3, v5, 4, v3
    v_add_u32 v3, 256, v3

    s_barrier
    s_add_u32 s21, s20, 3072
    s_waitcnt vmcnt(2)
    buffer_load_dwordx4 v[40:43], v1, s[8:11], s21 offen offset:0 nt
    s_waitcnt vmcnt(2)
    buffer_load_dwordx4 v[44:47], v1, s[8:11], s21 offen offset:128 nt
    s_waitcnt vmcnt(2)
    buffer_load_dwordx4 v[48:51], v1, s[8:11], s21 offen offset:256 nt
    s_add_u32 s21, s20, 6144
    s_waitcnt vmcnt(2)
    buffer_load_dwordx4 v[52:55], v1, s[8:11], s21 offen offset:0 nt
    s_waitcnt vmcnt(2)
    buffer_load_dwordx4 v[56:59], v1, s[8:11], s21 offen offset:128 nt
    s_waitcnt vmcnt(2)
    buffer_load_dwordx4 v[60:63], v1, s[8:11], s21 offen offset:256 nt
    s_add_u32 s21, s20, 9216
    s_waitcnt vmcnt(2)
    buffer_load_dwordx4 v[64:67], v1, s[8:11], s21 offen offset:0 nt
    s_waitcnt vmcnt(2)
    buffer_load_dwordx4 v[68:71], v1, s[8:11], s21 offen offset:128 nt
    s_waitcnt vmcnt(2)
    buffer_load_dwordx4 v[72:75], v1, s[8:11], s21 offen offset:256 nt
    s_add_u32 s21, s20, 12288
    s_waitcnt vmcnt(2)
    buffer_load_dwordx4 v[76:79], v1, s[8:11], s21 offen offset:0 nt
    s_waitcnt vmcnt(2)
    buffer_load_dwordx4 v[80:83], v1, s[8:11], s21 offen offset:128 nt
    s_waitcnt vmcnt(2)
    buffer_load_dwordx4 v[84:87], v1, s[8:11], s21 offen offset:256 nt
    s_add_u32 s21, s20, 15360
    s_waitcnt vmcnt(2)
    buffer_load_dwordx4 v[88:91], v1, s[8:11], s21 offen offset:0 nt
    s_waitcnt vmcnt(2)
    buffer_load_dwordx4 v[92:95], v1, s[8:11], s21 offen offset:128 nt
    s_waitcnt vmcnt(2)
    buffer_load_dwordx4 v[96:99], v1, s[8:11], s21 offen offset:256 nt
    s_add_u32 s21, s20, 18432
    s_waitcnt vmcnt(2)
    buffer_load_dwordx4 v[100:103], v1, s[8:11], s21 offen offset:0 nt
    s_waitcnt vmcnt(2)
    buffer_load_dwordx4 v[104:107], v1, s[8:11], s21 offen offset:128 nt
    s_waitcnt vmcnt(2)
    buffer_load_dwordx4 v[108:111], v1, s[8:11], s21 offen offset:256 nt
    s_add_u32 s21, s20, 21504
    s_waitcnt vmcnt(2)
    buffer_load_dwordx4 v[112:115], v1, s[8:11], s21 offen offset:0 nt
    s_waitcnt vmcnt(2)
    buffer_load_dwordx4 v[116:119], v1, s[8:11], s21 offen offset:128 nt
    s_waitcnt vmcnt(2)
    buffer_load_dwordx4 v[120:123], v1, s[8:11], s21 offen offset:256 nt
    s_lshr_b32 s97, s3, 8
    v_mov_b32 v25, 0
    s_waitcnt vmcnt(2)
    s_add_u32 s21, s20, 0
    buffer_load_dwordx4 v[124:127], v2, s[12:15], s21 offen nt
    s_waitcnt vmcnt(2)
    s_add_u32 s21, s20, 0
    buffer_load_dwordx4 v[128:131], v2, s[12:15], s21 offen offset:1536 nt
    s_waitcnt vmcnt(2)
    s_add_u32 s21, s20, 0
    buffer_load_dwordx4 v[132:135], v3, s[12:15], s21 offen nt
    s_cmp_lg_u32 s97, 0
    s_cbranch_scc1 QS_1
    ds_read_b32 v24, v25
    s_waitcnt lgkmcnt(0)
    v_readfirstlane_b32 s93, v24
    s_cmp_eq_u32 s93, 0
    s_cbranch_scc1 QS_1
    s_call_b64 s[30:31], L_QK

QS_1:
    s_waitcnt vmcnt(2)
    s_add_u32 s21, s20, 3072
    buffer_load_dwordx4 v[136:139], v2, s[12:15], s21 offen nt
    s_cmp_lg_u32 s97, 0
    s_cbranch_scc1 QS_2
    ds_read_b32 v24, v25
    s_waitcnt lgkmcnt(0)
    v_readfirstlane_b32 s93, v24
    s_cmp_eq_u32 s93, 0
    s_cbranch_scc1 QS_2
    s_call_b64 s[30:31], L_QK

QS_2:
    s_waitcnt vmcnt(2)
    s_add_u32 s21, s20, 3072
    buffer_load_dwordx4 v[140:143], v2, s[12:15], s21 offen offset:1536 nt
    s_cmp_lg_u32 s97, 0
    s_cbranch_scc1 QS_3
    ds_read_b32 v24, v25
    s_waitcnt lgkmcnt(0)
    v_readfirstlane_b32 s93, v24
    s_cmp_eq_u32 s93, 0
    s_cbranch_scc1 QS_3
    s_call_b64 s[30:31], L_QK

QS_3:
    s_waitcnt vmcnt(2)
    s_add_u32 s21, s20, 3072
    buffer_load_dwordx4 v[144:147], v3, s[12:15], s21 offen nt
    s_cmp_lg_u32 s97, 0
    s_cbranch_scc1 QS_4
    ds_read_b32 v24, v25
    s_waitcnt lgkmcnt(0)
    v_readfirstlane_b32 s93, v24
    s_cmp_eq_u32 s93, 0
    s_cbranch_scc1 QS_4
    s_call_b64 s[30:31], L_QK

QS_4:
    s_waitcnt vmcnt(2)
    s_add_u32 s21, s20, 6144
    buffer_load_dwordx4 v[148:151], v2, s[12:15], s21 offen nt
    s_cmp_lg_u32 s97, 0
    s_cbranch_scc1 QS_5
    ds_read_b32 v24, v25
    s_waitcnt lgkmcnt(0)
    v_readfirstlane_b32 s93, v24
    s_cmp_eq_u32 s93, 0
    s_cbranch_scc1 QS_5
    s_call_b64 s[30:31], L_QK

QS_5:
    s_waitcnt vmcnt(2)
    s_add_u32 s21, s20, 6144
    buffer_load_dwordx4 v[152:155], v2, s[12:15], s21 offen offset:1536 nt
    s_cmp_lg_u32 s97, 0
    s_cbranch_scc1 QS_6
    ds_read_b32 v24, v25
    s_waitcnt lgkmcnt(0)
    v_readfirstlane_b32 s93, v24
    s_cmp_eq_u32 s93, 0
    s_cbranch_scc1 QS_6
    s_call_b64 s[30:31], L_QK

QS_6:
    s_waitcnt vmcnt(2)
    s_add_u32 s21, s20, 6144
    buffer_load_dwordx4 v[156:159], v3, s[12:15], s21 offen nt
    s_cmp_lg_u32 s97, 0
    s_cbranch_scc1 QS_7
    ds_read_b32 v24, v25
    s_waitcnt lgkmcnt(0)
    v_readfirstlane_b32 s93, v24
    s_cmp_eq_u32 s93, 0
    s_cbranch_scc1 QS_7
    s_call_b64 s[30:31], L_QK

QS_7:
    s_waitcnt vmcnt(2)
    s_add_u32 s21, s20, 9216
    buffer_load_dwordx4 v[160:163], v2, s[12:15], s21 offen nt
    s_cmp_lg_u32 s97, 0
    s_cbranch_scc1 QS_8
    ds_read_b32 v24, v25
    s_waitcnt lgkmcnt(0)
    v_readfirstlane_b32 s93, v24
    s_cmp_eq_u32 s93, 0
    s_cbranch_scc1 QS_8
    s_call_b64 s[30:31], L_QK

QS_8:
    s_waitcnt vmcnt(2)
    s_add_u32 s21, s20, 9216
    buffer_load_dwordx4 v[164:167], v2, s[12:15], s21 offen offset:1536 nt
    s_cmp_lg_u32 s97, 0
    s_cbranch_scc1 L_QK_done
    v_mov_b32 v25, 0
    s_mov_b32 s95, 0
SP_9:
    ds_read_b32 v24, v25
    s_waitcnt lgkmcnt(0)
    v_readfirstlane_b32 s93, v24
    s_cmp_lg_u32 s93, 0
    s_cbranch_scc1 SPD_10
    s_sleep 2
    s_add_u32 s95, s95, 1
    s_cmp_lt_u32 s95, 0x40000
    s_cbranch_scc1 SP_9
SPD_10:
    s_call_b64 s[30:31], L_QK
    s_branch L_QK_done
L_QK:
    v_and_b32 v24, 1, v0
    v_lshrrev_b32 v25, 4, v0
    v_lshl_add_u32 v24, v24, 2, v25
    v_lshlrev_b32 v24, 4, v24
    ds_read_b128 v[4:7], v24 offset:256
    ds_read_b128 v[8:11], v24 offset:384
    ds_read_b128 v[12:15], v24 offset:512
    s_waitcnt lgkmcnt(0)

    v_mfma_f32_16x16x32_bf16 v[16:19], v[4:7], v[28:31], 0
    v_mfma_f32_16x16x32_bf16 v[16:19], v[8:11], v[32:35], v[16:19]
    v_mfma_f32_16x16x32_bf16 v[16:19], v[12:15], v[36:39], v[16:19]
    v_mfma_f32_16x16x32_bf16 v[20:23], v[4:7], v[40:43], 0
    v_mfma_f32_16x16x32_bf16 v[20:23], v[8:11], v[44:47], v[20:23]
    v_mfma_f32_16x16x32_bf16 v[20:23], v[12:15], v[48:51], v[20:23]
    s_nop 4
    v_add_f32_dpp v24, v17, v16 row_ror:8 row_mask:0x1 bank_mask:0x3
    s_nop 2
    v_mfma_f32_16x16x32_bf16 v[16:19], v[4:7], v[52:55], 0
    v_mfma_f32_16x16x32_bf16 v[16:19], v[8:11], v[56:59], v[16:19]
    v_mfma_f32_16x16x32_bf16 v[16:19], v[12:15], v[60:63], v[16:19]
    s_nop 4
    v_add_f32_dpp v24, v20, v21 row_ror:8 row_mask:0x1 bank_mask:0xc
    s_nop 2
    v_mfma_f32_16x16x32_bf16 v[20:23], v[4:7], v[64:67], 0
    v_mfma_f32_16x16x32_bf16 v[20:23], v[8:11], v[68:71], v[20:23]
    v_mfma_f32_16x16x32_bf16 v[20:23], v[12:15], v[72:75], v[20:23]
    s_nop 4
    v_add_f32_dpp v24, v17, v16 row_ror:8 row_mask:0x2 bank_mask:0x3
    s_nop 2
    v_mfma_f32_16x16x32_bf16 v[16:19], v[4:7], v[76:79], 0
    v_mfma_f32_16x16x32_bf16 v[16:19], v[8:11], v[80:83], v[16:19]
    v_mfma_f32_16x16x32_bf16 v[16:19], v[12:15], v[84:87], v[16:19]
    s_nop 4
    v_add_f32_dpp v24, v20, v21 row_ror:8 row_mask:0x2 bank_mask:0xc
    s_nop 2
    v_mfma_f32_16x16x32_bf16 v[20:23], v[4:7], v[88:91], 0
    v_mfma_f32_16x16x32_bf16 v[20:23], v[8:11], v[92:95], v[20:23]
    v_mfma_f32_16x16x32_bf16 v[20:23], v[12:15], v[96:99], v[20:23]
    s_nop 4
    v_add_f32_dpp v24, v17, v16 row_ror:8 row_mask:0x4 bank_mask:0x3
    s_nop 2
    v_mfma_f32_16x16x32_bf16 v[16:19], v[4:7], v[100:103], 0
    v_mfma_f32_16x16x32_bf16 v[16:19], v[8:11], v[104:107], v[16:19]
    v_mfma_f32_16x16x32_bf16 v[16:19], v[12:15], v[108:111], v[16:19]
    s_nop 4
    v_add_f32_dpp v24, v20, v21 row_ror:8 row_mask:0x4 bank_mask:0xc
    s_nop 2
    v_mfma_f32_16x16x32_bf16 v[20:23], v[4:7], v[112:115], 0
    v_mfma_f32_16x16x32_bf16 v[20:23], v[8:11], v[116:119], v[20:23]
    v_mfma_f32_16x16x32_bf16 v[20:23], v[12:15], v[120:123], v[20:23]
    s_nop 4
    v_add_f32_dpp v24, v17, v16 row_ror:8 row_mask:0x8 bank_mask:0x3
    s_nop 2
    s_nop 7
    v_add_f32_dpp v24, v20, v21 row_ror:8 row_mask:0x8 bank_mask:0xc
    s_nop 0
    v_cvt_pk_bf16_f32 v24, v24, v24
    v_and_b32 v24, 0xffff0000, v24
    v_mul_f32 v24, 0x3d93cd3a, v24
    v_cvt_pk_bf16_f32 v24, v24, v24
    v_and_b32 v24, 0xffff0000, v24
    v_mov_b32 v16, v24
    s_nop 1
    v_max_f32_dpp v16, v16, v16 row_ror:8 row_mask:0xf bank_mask:0xf
    s_nop 1
    v_max_f32_dpp v16, v16, v16 row_ror:4 row_mask:0xf bank_mask:0xf
    s_nop 1
    v_max_f32_dpp v16, v16, v16 row_ror:2 row_mask:0xf bank_mask:0xf
    s_nop 1
    v_max_f32_dpp v16, v16, v16 row_ror:1 row_mask:0xf bank_mask:0xf
    v_mov_b32 v17, v16
    s_nop 1
    v_permlane16_swap_b32 v16, v17
    v_max_f32 v16, v16, v17
    v_mov_b32 v17, v16
    s_nop 1
    v_permlane32_swap_b32 v16, v17
    v_max_f32 v16, v16, v17
    v_sub_f32 v18, v24, v16
    v_max_f32 v18, 0xc3480000, v18
    v_mul_f32 v19, 0x3fb8aa3b, v18
    v_fma_f32 v20, v18, s94, -v19
    v_fmac_f32 v20, 0x32a57060, v18
    v_exp_f32 v19, v19
    v_mul_f32 v20, 0x3f317218, v20
    v_fma_f32 v17, v19, v20, v19

    s_nop 1
    v_add_f32_dpp v17, v17, v17 row_ror:8 row_mask:0xf bank_mask:0xf
    s_nop 1
    v_add_f32_dpp v17, v17, v17 row_ror:4 row_mask:0xf bank_mask:0xf
    s_nop 1
    v_add_f32_dpp v17, v17, v17 row_ror:2 row_mask:0xf bank_mask:0xf
    s_nop 1
    v_add_f32_dpp v17, v17, v17 row_ror:1 row_mask:0xf bank_mask:0xf
    v_mov_b32 v18, v17
    s_nop 1
    v_permlane16_swap_b32 v17, v18
    v_add_f32 v17, v17, v18
    v_mov_b32 v18, v17
    s_nop 1
    v_permlane32_swap_b32 v17, v18
    v_add_f32 v17, v17, v18
    s_lshl_b32 s21, s3, 3
    s_add_u32 s21, s21, 1024
    v_mov_b32 v18, s21
    ds_write_b64 v18, v[16:17]
    s_waitcnt lgkmcnt(0)

    v_mov_b32 v18, 4
    v_mov_b32 v19, 1
    s_mov_b64 exec, 1
    ds_add_u32 v18, v19
    s_mov_b64 exec, -1
    s_or_b32 s97, s3, 256
    s_setpc_b64 s[30:31]
L_QK_done:
    s_waitcnt vmcnt(2)
    s_add_u32 s21, s20, 9216
    buffer_load_dwordx4 v[28:31], v3, s[12:15], s21 offen nt
    s_waitcnt vmcnt(2)
    s_add_u32 s21, s20, 12288
    buffer_load_dwordx4 v[32:35], v2, s[12:15], s21 offen nt
    s_waitcnt vmcnt(2)
    s_add_u32 s21, s20, 12288
    buffer_load_dwordx4 v[36:39], v2, s[12:15], s21 offen offset:1536 nt
    s_waitcnt vmcnt(2)
    s_add_u32 s21, s20, 12288
    buffer_load_dwordx4 v[40:43], v3, s[12:15], s21 offen nt
    s_waitcnt vmcnt(2)
    s_add_u32 s21, s20, 15360
    buffer_load_dwordx4 v[44:47], v2, s[12:15], s21 offen nt
    s_waitcnt vmcnt(2)
    s_add_u32 s21, s20, 15360
    buffer_load_dwordx4 v[48:51], v2, s[12:15], s21 offen offset:1536 nt
    s_waitcnt vmcnt(2)
    s_add_u32 s21, s20, 15360
    buffer_load_dwordx4 v[52:55], v3, s[12:15], s21 offen nt
    s_waitcnt vmcnt(2)
    s_add_u32 s21, s20, 18432
    buffer_load_dwordx4 v[56:59], v2, s[12:15], s21 offen nt
    s_waitcnt vmcnt(2)
    s_add_u32 s21, s20, 18432
    buffer_load_dwordx4 v[60:63], v2, s[12:15], s21 offen offset:1536 nt
    s_waitcnt vmcnt(2)
    s_add_u32 s21, s20, 18432
    buffer_load_dwordx4 v[64:67], v3, s[12:15], s21 offen nt
    s_waitcnt vmcnt(2)
    s_add_u32 s21, s20, 21504
    buffer_load_dwordx4 v[68:71], v2, s[12:15], s21 offen nt
    s_waitcnt vmcnt(2)
    s_add_u32 s21, s20, 21504
    buffer_load_dwordx4 v[72:75], v2, s[12:15], s21 offen offset:1536 nt
    v_mov_b32 v4, 40
    v_mov_b32 v5, 1
    s_mov_b64 exec, 1
    ds_add_u32 v4, v5
    s_mov_b64 exec, -1
    s_waitcnt vmcnt(2)
    s_add_u32 s21, s20, 21504
    buffer_load_dwordx4 v[76:79], v3, s[12:15], s21 offen nt
    v_and_b32 v25, 1, v0
    v_lshlrev_b32 v25, 4, v25
    v_mov_b32 v26, 0xffff
    v_lshlrev_b32 v25, v25, v26
    v_bfe_u32 v26, v0, 1, 2

    v_cmp_eq_u32 vcc, 0, v26
    s_nop 1
    v_cndmask_b32 v16, 0, v25, vcc
    v_cmp_eq_u32 vcc, 1, v26
    s_nop 1
    v_cndmask_b32 v17, 0, v25, vcc
    v_cmp_eq_u32 vcc, 2, v26
    s_nop 1
    v_cndmask_b32 v18, 0, v25, vcc
    v_cmp_eq_u32 vcc, 3, v26
    s_nop 1
    v_cndmask_b32 v19, 0, v25, vcc
    s_lshl_b32 s22, s3, 8
    s_add_u32 s22, s22, 2048
    v_lshrrev_b32 v1, 4, v0
    v_bfe_u32 v25, v0, 3, 1
    v_lshl_add_u32 v1, v25, 2, v1
    v_lshlrev_b32 v1, 2, v1
    v_add_u32 v1, s22, v1

    v_mov_b32 v26, 8
    s_mov_b32 s95, 0
SP_11:
    ds_read_b32 v25, v26
    s_waitcnt lgkmcnt(0)
    v_readfirstlane_b32 s93, v25
    s_cmp_lg_u32 s93, 0
    s_cbranch_scc1 SPD_12
    s_sleep 2
    s_add_u32 s95, s95, 1
    s_cmp_lt_u32 s95, 0x40000
    s_cbranch_scc1 SP_11
SPD_12:
    v_mov_b32 v25, 1152
    ds_read_b64 v[26:27], v25
    v_mov_b32 v25, 12
    ds_read_b32 v25, v25
    v_lshlrev_b32 v2, 2, v0
    v_add_u32 v2, s22, v2
    s_waitcnt lgkmcnt(0)
    v_readfirstlane_b32 s45, v25
    v_sub_f32 v24, v24, v26
    s_and_b32 s45, s45, 3
    v_max_f32 v24, 0xc3480000, v24

    v_mul_f32 v20, 0x3fb8aa3b, v24
    v_fma_f32 v21, v24, s94, -v20
    v_fmac_f32 v21, 0x32a57060, v24
    v_exp_f32 v20, v20
    v_mul_f32 v21, 0x3f317218, v21
    v_fma_f32 v24, v20, v21, v20

    v_rcp_f32 v20, v27
    s_nop 0
    v_mul_f32 v21, v24, v20
    v_fma_f32 v24, -v21, v27, v24
    v_fma_f32 v24, v24, v20, v21

    v_cvt_pk_bf16_f32 v24, v24, v24
    ds_write_b32 v2, v24
    s_waitcnt lgkmcnt(0)
    ds_read_b32 v2, v1 offset:0
    ds_read_b32 v3, v1 offset:32
    s_setprio 3

    s_waitcnt lgkmcnt(1)
    v_and_b32 v20, v2, v16
    v_and_b32 v21, v2, v17
    v_and_b32 v22, v2, v18
    v_and_b32 v23, v2, v19
    ds_read_b32 v2, v1 offset:64
    s_nop 0
    v_mfma_f32_16x16x32_bf16 v[4:7], v[20:23], v[124:127], 0
    v_mfma_f32_16x16x32_bf16 v[8:11], v[20:23], v[128:131], 0
    v_mfma_f32_16x16x32_bf16 v[12:15], v[20:23], v[132:135], 0
    s_waitcnt lgkmcnt(1)
    v_and_b32 v24, v3, v16
    v_and_b32 v25, v3, v17
    v_and_b32 v26, v3, v18
    v_and_b32 v27, v3, v19
    ds_read_b32 v3, v1 offset:96
    s_nop 0
    v_mfma_f32_16x16x32_bf16 v[4:7], v[24:27], v[136:139], v[4:7]
    v_mfma_f32_16x16x32_bf16 v[8:11], v[24:27], v[140:143], v[8:11]
    v_mfma_f32_16x16x32_bf16 v[12:15], v[24:27], v[144:147], v[12:15]
    s_waitcnt lgkmcnt(1)
    v_and_b32 v20, v2, v16
    v_and_b32 v21, v2, v17
    v_and_b32 v22, v2, v18
    v_and_b32 v23, v2, v19
    ds_read_b32 v2, v1 offset:128
    s_nop 0
    v_mfma_f32_16x16x32_bf16 v[4:7], v[20:23], v[148:151], v[4:7]
    v_mfma_f32_16x16x32_bf16 v[8:11], v[20:23], v[152:155], v[8:11]
    v_mfma_f32_16x16x32_bf16 v[12:15], v[20:23], v[156:159], v[12:15]
    s_waitcnt lgkmcnt(1)
    v_and_b32 v24, v3, v16
    v_and_b32 v25, v3, v17
    v_and_b32 v26, v3, v18
    v_and_b32 v27, v3, v19
    ds_read_b32 v3, v1 offset:160
    s_nop 0
    v_mfma_f32_16x16x32_bf16 v[4:7], v[24:27], v[160:163], v[4:7]
    v_mfma_f32_16x16x32_bf16 v[8:11], v[24:27], v[164:167], v[8:11]
    v_mfma_f32_16x16x32_bf16 v[12:15], v[24:27], v[28:31], v[12:15]
    s_waitcnt lgkmcnt(1)
    v_and_b32 v20, v2, v16
    v_and_b32 v21, v2, v17
    v_and_b32 v22, v2, v18
    v_and_b32 v23, v2, v19
    ds_read_b32 v2, v1 offset:192
    s_nop 0
    v_mfma_f32_16x16x32_bf16 v[4:7], v[20:23], v[32:35], v[4:7]
    v_mfma_f32_16x16x32_bf16 v[8:11], v[20:23], v[36:39], v[8:11]
    v_mfma_f32_16x16x32_bf16 v[12:15], v[20:23], v[40:43], v[12:15]
    s_waitcnt lgkmcnt(1)
    v_and_b32 v24, v3, v16
    v_and_b32 v25, v3, v17
    v_and_b32 v26, v3, v18
    v_and_b32 v27, v3, v19
    ds_read_b32 v3, v1 offset:224
    s_nop 0
    v_mfma_f32_16x16x32_bf16 v[4:7], v[24:27], v[44:47], v[4:7]
    v_mfma_f32_16x16x32_bf16 v[8:11], v[24:27], v[48:51], v[8:11]
    v_mfma_f32_16x16x32_bf16 v[12:15], v[24:27], v[52:55], v[12:15]
    s_waitcnt lgkmcnt(1)
    v_and_b32 v20, v2, v16
    v_and_b32 v21, v2, v17
    v_and_b32 v22, v2, v18
    v_and_b32 v23, v2, v19
    s_nop 1
    v_mfma_f32_16x16x32_bf16 v[4:7], v[20:23], v[56:59], v[4:7]
    v_mfma_f32_16x16x32_bf16 v[8:11], v[20:23], v[60:63], v[8:11]
    v_mfma_f32_16x16x32_bf16 v[12:15], v[20:23], v[64:67], v[12:15]
    s_waitcnt lgkmcnt(0)
    v_and_b32 v24, v3, v16
    v_and_b32 v25, v3, v17
    v_and_b32 v26, v3, v18
    v_and_b32 v27, v3, v19
    v_mov_b32 v1, 20
    v_mov_b32 v2, 1
    s_mov_b64 exec, 1
    ds_add_u32 v1, v2
    s_mov_b64 exec, -1
    v_and_b32 v2, 15, v0
    v_lshrrev_b32 v3, 4, v0
    v_lshlrev_b32 v1, 5, v2
    v_lshl_add_u32 v1, v3, 4, v1
    v_add_u32 v2, 224, v1
    v_cmp_gt_u32 vcc, 32, v0
    v_mov_b32 v3, 2147483632
    s_nop 0
    v_cndmask_b32 v1, v2, v1, vcc
    v_and_b32 v2, 40, v0
    v_cmp_eq_u32 vcc, 32, v2
    s_nop 1
    v_cndmask_b32 v1, v1, v3, vcc

    v_min_u32 v2, 1008, v1
    s_lshl_b32 s21, s3, 10
    v_add_u32 v3, s21, v2
    v_mov_b32 v16, 28
    v_mov_b32 v17, 1
    s_mul_i32 s21, s6, 768
    s_add_u32 s21, s21, 327680

    s_waitcnt vmcnt(2)
    v_mfma_f32_16x16x32_bf16 v[4:7], v[24:27], v[68:71], v[4:7]
    s_waitcnt vmcnt(1)
    v_mfma_f32_16x16x32_bf16 v[8:11], v[24:27], v[72:75], v[8:11]
    s_waitcnt vmcnt(0)
    v_mfma_f32_16x16x32_bf16 v[12:15], v[24:27], v[76:79], v[12:15]
    s_nop 7
    v_permlane32_swap_b32 v8, v12
    v_permlane32_swap_b32 v9, v13
    v_permlane32_swap_b32 v10, v14
    v_permlane32_swap_b32 v11, v15
    v_add_f32 v4, v4, v12
    v_add_f32 v5, v5, v13
    v_add_f32 v6, v6, v14
    v_add_f32 v7, v7, v15
    v_add_f32_dpp v4, v8, v12 row_ror:8 row_mask:0xc bank_mask:0xf
    v_add_f32_dpp v5, v9, v13 row_ror:8 row_mask:0xc bank_mask:0xf
    v_add_f32_dpp v6, v10, v14 row_ror:8 row_mask:0xc bank_mask:0xf
    v_add_f32_dpp v7, v11, v15 row_ror:8 row_mask:0xc bank_mask:0xf
    ds_write_b128 v3, v[4:7] offset:6144
    s_waitcnt lgkmcnt(0)
    s_mov_b64 exec, 1
    ds_add_rtn_u32 v17, v16, v17
    s_mov_b64 exec, -1
    s_waitcnt lgkmcnt(0)
    v_readfirstlane_b32 s22, v17
    s_cmp_lg_u32 s22, 7
    s_cbranch_scc1 L_S_end

    ds_read_b128 v[28:31], v2 offset:6144
    ds_read_b128 v[32:35], v2 offset:7168
    ds_read_b128 v[36:39], v2 offset:8192
    ds_read_b128 v[40:43], v2 offset:9216
    ds_read_b128 v[44:47], v2 offset:10240
    ds_read_b128 v[48:51], v2 offset:11264
    ds_read_b128 v[52:55], v2 offset:12288
    ds_read_b128 v[56:59], v2 offset:13312
    s_waitcnt lgkmcnt(6)
    v_pk_add_f32 v[28:29], v[28:29], v[32:33]
    v_pk_add_f32 v[30:31], v[30:31], v[34:35]
    s_waitcnt lgkmcnt(4)
    v_pk_add_f32 v[36:37], v[36:37], v[40:41]
    v_pk_add_f32 v[38:39], v[38:39], v[42:43]
    s_waitcnt lgkmcnt(2)
    v_pk_add_f32 v[44:45], v[44:45], v[48:49]
    v_pk_add_f32 v[46:47], v[46:47], v[50:51]
    s_waitcnt lgkmcnt(0)
    v_pk_add_f32 v[52:53], v[52:53], v[56:57]
    v_pk_add_f32 v[54:55], v[54:55], v[58:59]
    v_pk_add_f32 v[28:29], v[28:29], v[36:37]
    v_pk_add_f32 v[30:31], v[30:31], v[38:39]
    v_pk_add_f32 v[44:45], v[44:45], v[52:53]
    v_pk_add_f32 v[46:47], v[46:47], v[54:55]
    v_pk_add_f32 v[28:29], v[28:29], v[44:45]
    v_pk_add_f32 v[30:31], v[30:31], v[46:47]
    v_min_u32 v28, -2, v28
    v_min_u32 v29, -2, v29
    v_min_u32 v30, -2, v30
    v_min_u32 v31, -2, v31

    s_cmp_eq_u32 s45, 1
    s_cbranch_scc0 SF_13
    buffer_store_dwordx4 v[28:31], v1, s[16:19], s21 offen
SJ_14:
    s_branch L_S_end2
L_S_end:
L_S_end2:
    s_endpgm
L_A0:
    s_setprio 2
    s_mov_b32 s8, s68
    s_mov_b32 s9, s69
    s_mov_b32 s10, 4915200
    s_mov_b32 s11, 0x20000
    s_mov_b32 s12, s66
    s_mov_b32 s13, s67
    s_mov_b32 s14, 1280
    s_mov_b32 s15, 0x20000
    v_lshlrev_b32 v1, 2, v0
    v_mov_b32 v2, 0
    ds_write_b32 v1, v2
    s_cmp_ge_u32 s2, 240
    s_cbranch_scc1 L_A0_bar
    s_and_b32 s20, s2, 3
    s_lshr_b32 s21, s2, 2

    s_mul_i32 s22, s20, 1228800
    s_lshl_b32 s23, s21, 7
    s_add_u32 s22, s22, s23
    v_lshrrev_b32 v4, 4, v0
    v_bfe_u32 v5, v0, 3, 1
    v_lshl_add_u32 v4, v5, 2, v4
    v_mul_u32_u24 v4, 7680, v4
    v_and_b32 v5, 7, v0
    v_lshl_add_u32 v4, v5, 4, v4
    s_mul_i32 s24, s20, 320
    v_lshlrev_b32 v5, 1, v0
    buffer_load_ushort v6, v5, s[12:15], s24 offen
    buffer_load_ushort v7, v5, s[12:15], s24 offen offset:128
    buffer_load_ushort v8, v5, s[12:15], s24 offen offset:256

    s_add_u32 s23, s22, 0
    buffer_load_dwordx4 v[40:43], v4, s[8:11], s23 offen nt
    s_add_u32 s23, s22, 61440
    buffer_load_dwordx4 v[44:47], v4, s[8:11], s23 offen nt
    s_add_u32 s23, s22, 122880
    buffer_load_dwordx4 v[48:51], v4, s[8:11], s23 offen nt
    s_add_u32 s23, s22, 184320
    buffer_load_dwordx4 v[52:55], v4, s[8:11], s23 offen nt
    s_add_u32 s23, s22, 245760
    buffer_load_dwordx4 v[56:59], v4, s[8:11], s23 offen nt
    s_add_u32 s23, s22, 307200
    buffer_load_dwordx4 v[60:63], v4, s[8:11], s23 offen nt
    s_add_u32 s23, s22, 368640
    buffer_load_dwordx4 v[64:67], v4, s[8:11], s23 offen nt
    s_add_u32 s23, s22, 430080
    buffer_load_dwordx4 v[68:71], v4, s[8:11], s23 offen nt
    s_add_u32 s23, s22, 491520
    buffer_load_dwordx4 v[72:75], v4, s[8:11], s23 offen nt
    s_add_u32 s23, s22, 552960
    buffer_load_dwordx4 v[76:79], v4, s[8:11], s23 offen nt
    s_add_u32 s23, s22, 614400
    buffer_load_dwordx4 v[80:83], v4, s[8:11], s23 offen nt
    s_add_u32 s23, s22, 675840
    buffer_load_dwordx4 v[84:87], v4, s[8:11], s23 offen nt
    s_add_u32 s23, s22, 737280
    buffer_load_dwordx4 v[88:91], v4, s[8:11], s23 offen nt
    s_add_u32 s23, s22, 798720
    buffer_load_dwordx4 v[92:95], v4, s[8:11], s23 offen nt
    s_add_u32 s23, s22, 860160
    buffer_load_dwordx4 v[96:99], v4, s[8:11], s23 offen nt
    s_add_u32 s23, s22, 921600
    buffer_load_dwordx4 v[100:103], v4, s[8:11], s23 offen nt
    s_add_u32 s23, s22, 983040
    buffer_load_dwordx4 v[104:107], v4, s[8:11], s23 offen nt
    s_add_u32 s23, s22, 1044480
    buffer_load_dwordx4 v[108:111], v4, s[8:11], s23 offen nt
    s_add_u32 s23, s22, 1105920
    buffer_load_dwordx4 v[112:115], v4, s[8:11], s23 offen nt
    s_add_u32 s23, s22, 1167360
    buffer_load_dwordx4 v[116:119], v4, s[8:11], s23 offen nt
L_A0_bar:
    s_waitcnt lgkmcnt(0)
    s_barrier
    s_cmp_ge_u32 s2, 240
    s_cbranch_scc1 L_A0_stats
    v_and_b32 v9, 1, v0
    v_lshlrev_b32 v9, 4, v9
    v_mov_b32 v10, 0xffff
    v_lshlrev_b32 v9, v9, v10
    v_bfe_u32 v10, v0, 1, 2

    v_cmp_eq_u32 vcc, 0, v10
    s_nop 1
    v_cndmask_b32 v16, 0, v9, vcc
    v_cmp_eq_u32 vcc, 1, v10
    s_nop 1
    v_cndmask_b32 v17, 0, v9, vcc
    v_cmp_eq_u32 vcc, 2, v10
    s_nop 1
    v_cndmask_b32 v18, 0, v9, vcc
    v_cmp_eq_u32 vcc, 3, v10
    s_nop 1
    v_cndmask_b32 v19, 0, v9, vcc
    v_lshrrev_b32 v1, 4, v0
    v_bfe_u32 v9, v0, 3, 1
    v_lshl_add_u32 v1, v9, 2, v1
    v_lshlrev_b32 v1, 2, v1
    v_add_u32 v1, 4096, v1

    s_waitcnt vmcnt(20)
    v_lshlrev_b32 v6, 16, v6
    v_sub_f32 v9, 0, v6
    v_min_f32 v9, 0x42b00000, v9
    v_max_f32 v9, 0xc3480000, v9
    v_mul_f32 v11, 0x3fb8aa3b, v9
    v_fma_f32 v12, v9, s94, -v11
    v_fmac_f32 v12, 0x32a57060, v9
    v_exp_f32 v11, v11
    v_mul_f32 v12, 0x3f317218, v12
    v_fma_f32 v10, v11, v12, v11

    v_add_f32 v10, 1.0, v10
    v_rcp_f32 v11, v10
    s_nop 0
    v_mul_f32 v12, v6, v11
    v_fma_f32 v6, -v12, v10, v6
    v_fma_f32 v6, v6, v11, v12

    v_cvt_pk_bf16_f32 v6, v6, v6
    v_lshlrev_b32 v7, 16, v7
    v_sub_f32 v9, 0, v7
    v_min_f32 v9, 0x42b00000, v9
    v_max_f32 v9, 0xc3480000, v9
    v_mul_f32 v11, 0x3fb8aa3b, v9
    v_fma_f32 v12, v9, s94, -v11
    v_fmac_f32 v12, 0x32a57060, v9
    v_exp_f32 v11, v11
    v_mul_f32 v12, 0x3f317218, v12
    v_fma_f32 v10, v11, v12, v11

    v_add_f32 v10, 1.0, v10
    v_rcp_f32 v11, v10
    s_nop 0
    v_mul_f32 v12, v7, v11
    v_fma_f32 v7, -v12, v10, v7
    v_fma_f32 v7, v7, v11, v12

    v_cvt_pk_bf16_f32 v7, v7, v7
    v_lshlrev_b32 v8, 16, v8
    v_sub_f32 v9, 0, v8
    v_min_f32 v9, 0x42b00000, v9
    v_max_f32 v9, 0xc3480000, v9
    v_mul_f32 v11, 0x3fb8aa3b, v9
    v_fma_f32 v12, v9, s94, -v11
    v_fmac_f32 v12, 0x32a57060, v9
    v_exp_f32 v11, v11
    v_mul_f32 v12, 0x3f317218, v12
    v_fma_f32 v10, v11, v12, v11

    v_add_f32 v10, 1.0, v10
    v_rcp_f32 v11, v10
    s_nop 0
    v_mul_f32 v12, v8, v11
    v_fma_f32 v8, -v12, v10, v8
    v_fma_f32 v8, v8, v11, v12

    v_cvt_pk_bf16_f32 v8, v8, v8
    v_lshlrev_b32 v9, 2, v0
    ds_write_b32 v9, v6 offset:4096
    ds_write_b32 v9, v7 offset:4352
    ds_write_b32 v9, v8 offset:4608
    s_waitcnt lgkmcnt(0)
    ds_read_b32 v2, v1 offset:0
    ds_read_b32 v3, v1 offset:32

    s_waitcnt lgkmcnt(1)
    v_and_b32 v20, v2, v16
    v_and_b32 v21, v2, v17
    v_and_b32 v22, v2, v18
    v_and_b32 v23, v2, v19
    ds_read_b32 v2, v1 offset:64
    s_nop 0
    s_waitcnt vmcnt(19)
    v_mfma_f32_16x16x32_bf16 v[4:7], v[20:23], v[40:43], 0
    s_waitcnt lgkmcnt(1)
    v_and_b32 v24, v3, v16
    v_and_b32 v25, v3, v17
    v_and_b32 v26, v3, v18
    v_and_b32 v27, v3, v19
    ds_read_b32 v3, v1 offset:96
    s_nop 0
    s_waitcnt vmcnt(18)
    v_mfma_f32_16x16x32_bf16 v[4:7], v[24:27], v[44:47], v[4:7]
    s_waitcnt lgkmcnt(1)
    v_and_b32 v20, v2, v16
    v_and_b32 v21, v2, v17
    v_and_b32 v22, v2, v18
    v_and_b32 v23, v2, v19
    ds_read_b32 v2, v1 offset:128
    s_nop 0
    s_waitcnt vmcnt(17)
    v_mfma_f32_16x16x32_bf16 v[4:7], v[20:23], v[48:51], v[4:7]
    s_waitcnt lgkmcnt(1)
    v_and_b32 v24, v3, v16
    v_and_b32 v25, v3, v17
    v_and_b32 v26, v3, v18
    v_and_b32 v27, v3, v19
    ds_read_b32 v3, v1 offset:160
    s_nop 0
    s_waitcnt vmcnt(16)
    v_mfma_f32_16x16x32_bf16 v[4:7], v[24:27], v[52:55], v[4:7]
    s_waitcnt lgkmcnt(1)
    v_and_b32 v20, v2, v16
    v_and_b32 v21, v2, v17
    v_and_b32 v22, v2, v18
    v_and_b32 v23, v2, v19
    ds_read_b32 v2, v1 offset:192
    s_nop 0
    s_waitcnt vmcnt(15)
    v_mfma_f32_16x16x32_bf16 v[4:7], v[20:23], v[56:59], v[4:7]
    s_waitcnt lgkmcnt(1)
    v_and_b32 v24, v3, v16
    v_and_b32 v25, v3, v17
    v_and_b32 v26, v3, v18
    v_and_b32 v27, v3, v19
    ds_read_b32 v3, v1 offset:224
    s_nop 0
    s_waitcnt vmcnt(14)
    v_mfma_f32_16x16x32_bf16 v[4:7], v[24:27], v[60:63], v[4:7]
    s_waitcnt lgkmcnt(1)
    v_and_b32 v20, v2, v16
    v_and_b32 v21, v2, v17
    v_and_b32 v22, v2, v18
    v_and_b32 v23, v2, v19
    ds_read_b32 v2, v1 offset:256
    s_nop 0
    s_waitcnt vmcnt(13)
    v_mfma_f32_16x16x32_bf16 v[4:7], v[20:23], v[64:67], v[4:7]
    s_waitcnt lgkmcnt(1)
    v_and_b32 v24, v3, v16
    v_and_b32 v25, v3, v17
    v_and_b32 v26, v3, v18
    v_and_b32 v27, v3, v19
    ds_read_b32 v3, v1 offset:288
    s_nop 0
    s_waitcnt vmcnt(12)
    v_mfma_f32_16x16x32_bf16 v[4:7], v[24:27], v[68:71], v[4:7]
    s_waitcnt lgkmcnt(1)
    v_and_b32 v20, v2, v16
    v_and_b32 v21, v2, v17
    v_and_b32 v22, v2, v18
    v_and_b32 v23, v2, v19
    ds_read_b32 v2, v1 offset:320
    s_nop 0
    s_waitcnt vmcnt(11)
    v_mfma_f32_16x16x32_bf16 v[4:7], v[20:23], v[72:75], v[4:7]
    s_waitcnt lgkmcnt(1)
    v_and_b32 v24, v3, v16
    v_and_b32 v25, v3, v17
    v_and_b32 v26, v3, v18
    v_and_b32 v27, v3, v19
    ds_read_b32 v3, v1 offset:352
    s_nop 0
    s_waitcnt vmcnt(10)
    v_mfma_f32_16x16x32_bf16 v[4:7], v[24:27], v[76:79], v[4:7]
    s_waitcnt lgkmcnt(1)
    v_and_b32 v20, v2, v16
    v_and_b32 v21, v2, v17
    v_and_b32 v22, v2, v18
    v_and_b32 v23, v2, v19
    ds_read_b32 v2, v1 offset:384
    s_nop 0
    s_waitcnt vmcnt(9)
    v_mfma_f32_16x16x32_bf16 v[4:7], v[20:23], v[80:83], v[4:7]
    s_waitcnt lgkmcnt(1)
    v_and_b32 v24, v3, v16
    v_and_b32 v25, v3, v17
    v_and_b32 v26, v3, v18
    v_and_b32 v27, v3, v19
    ds_read_b32 v3, v1 offset:416
    s_nop 0
    s_waitcnt vmcnt(8)
    v_mfma_f32_16x16x32_bf16 v[4:7], v[24:27], v[84:87], v[4:7]
    s_waitcnt lgkmcnt(1)
    v_and_b32 v20, v2, v16
    v_and_b32 v21, v2, v17
    v_and_b32 v22, v2, v18
    v_and_b32 v23, v2, v19
    ds_read_b32 v2, v1 offset:448
    s_nop 0
    s_waitcnt vmcnt(7)
    v_mfma_f32_16x16x32_bf16 v[4:7], v[20:23], v[88:91], v[4:7]
    s_waitcnt lgkmcnt(1)
    v_and_b32 v24, v3, v16
    v_and_b32 v25, v3, v17
    v_and_b32 v26, v3, v18
    v_and_b32 v27, v3, v19
    ds_read_b32 v3, v1 offset:480
    s_nop 0
    s_waitcnt vmcnt(6)
    v_mfma_f32_16x16x32_bf16 v[4:7], v[24:27], v[92:95], v[4:7]
    s_waitcnt lgkmcnt(1)
    v_and_b32 v20, v2, v16
    v_and_b32 v21, v2, v17
    v_and_b32 v22, v2, v18
    v_and_b32 v23, v2, v19
    ds_read_b32 v2, v1 offset:512
    s_nop 0
    s_waitcnt vmcnt(5)
    v_mfma_f32_16x16x32_bf16 v[4:7], v[20:23], v[96:99], v[4:7]
    s_waitcnt lgkmcnt(1)
    v_and_b32 v24, v3, v16
    v_and_b32 v25, v3, v17
    v_and_b32 v26, v3, v18
    v_and_b32 v27, v3, v19
    ds_read_b32 v3, v1 offset:544
    s_nop 0
    s_waitcnt vmcnt(4)
    v_mfma_f32_16x16x32_bf16 v[4:7], v[24:27], v[100:103], v[4:7]
    s_waitcnt lgkmcnt(1)
    v_and_b32 v20, v2, v16
    v_and_b32 v21, v2, v17
    v_and_b32 v22, v2, v18
    v_and_b32 v23, v2, v19
    ds_read_b32 v2, v1 offset:576
    s_nop 0
    s_waitcnt vmcnt(3)
    v_mfma_f32_16x16x32_bf16 v[4:7], v[20:23], v[104:107], v[4:7]
    s_waitcnt lgkmcnt(1)
    v_and_b32 v24, v3, v16
    v_and_b32 v25, v3, v17
    v_and_b32 v26, v3, v18
    v_and_b32 v27, v3, v19
    ds_read_b32 v3, v1 offset:608
    s_nop 0
    s_waitcnt vmcnt(2)
    v_mfma_f32_16x16x32_bf16 v[4:7], v[24:27], v[108:111], v[4:7]
    s_waitcnt lgkmcnt(1)
    v_and_b32 v20, v2, v16
    v_and_b32 v21, v2, v17
    v_and_b32 v22, v2, v18
    v_and_b32 v23, v2, v19
    s_nop 0
    s_nop 0
    s_waitcnt vmcnt(1)
    v_mfma_f32_16x16x32_bf16 v[4:7], v[20:23], v[112:115], v[4:7]
    s_waitcnt lgkmcnt(0)
    v_and_b32 v24, v3, v16
    v_and_b32 v25, v3, v17
    v_and_b32 v26, v3, v18
    v_and_b32 v27, v3, v19
    s_nop 0
    s_nop 0
    s_waitcnt vmcnt(0)
    v_mfma_f32_16x16x32_bf16 v[4:7], v[24:27], v[116:119], v[4:7]
    v_and_b32 v9, 15, v0
    v_lshrrev_b32 v10, 4, v0
    v_lshlrev_b32 v1, 5, v9
    v_lshl_add_u32 v1, v10, 4, v1
    v_and_b32 v9, 40, v0
    v_cmp_eq_u32 vcc, 0, v9
    v_mov_b32 v10, 2147483632
    s_nop 0
    v_cndmask_b32 v1, v10, v1, vcc
    s_nop 2

    v_permlane32_swap_b32 v4, v8
    v_permlane32_swap_b32 v5, v9
    v_permlane32_swap_b32 v6, v10
    v_permlane32_swap_b32 v7, v11
    s_nop 1
    v_add_f32_dpp v4, v8, v4 row_ror:8 row_mask:0xf bank_mask:0xf
    v_add_f32_dpp v5, v9, v5 row_ror:8 row_mask:0xf bank_mask:0xf
    v_add_f32_dpp v6, v10, v6 row_ror:8 row_mask:0xf bank_mask:0xf
    v_add_f32_dpp v7, v11, v7 row_ror:8 row_mask:0xf bank_mask:0xf
    v_min_u32 v4, -2, v4
    v_min_u32 v5, -2, v5
    v_min_u32 v6, -2, v6
    v_min_u32 v7, -2, v7
    v_mov_b32 v10, 16
    s_mov_b32 s95, 0
SP_15:
    ds_read_b32 v9, v10
    s_waitcnt lgkmcnt(0)
    v_readfirstlane_b32 s93, v9
    s_cmp_lg_u32 s93, 0
    s_cbranch_scc1 SPD_16
    s_sleep 1
    s_add_u32 s95, s95, 1
    s_cmp_lt_u32 s95, 0x40000
    s_cbranch_scc1 SP_15
SPD_16:
    s_mul_i32 s22, s20, 15360
    s_lshl_b32 s23, s21, 8
    s_add_u32 s22, s22, s23
    s_add_u32 s22, s22, 0
    buffer_store_dwordx4 v[4:7], v1, s[16:19], s22 offen sc1

L_A0_stats:
    v_mov_b32 v10, 12
    s_mov_b32 s95, 0
SP_17:
    ds_read_b32 v9, v10
    s_waitcnt lgkmcnt(0)
    v_readfirstlane_b32 s93, v9
    s_cmp_lg_u32 s93, 0
    s_cbranch_scc1 SPD_18
    s_sleep 4
    s_add_u32 s95, s95, 1
    s_cmp_lt_u32 s95, 0x40000
    s_cbranch_scc1 SP_17
SPD_18:
    s_and_b32 s45, s93, 3
    v_mov_b32 v10, 4
    s_mov_b32 s95, 0
SP_19:
    ds_read_b32 v9, v10
    s_waitcnt lgkmcnt(0)
    v_readfirstlane_b32 s93, v9
    s_cmp_eq_u32 s93, 8
    s_cbranch_scc1 SPD_20
    s_sleep 2
    s_add_u32 s95, s95, 1
    s_cmp_lt_u32 s95, 0x40000
    s_cbranch_scc1 SP_19
SPD_20:
    v_and_b32 v1, 7, v0
    v_lshlrev_b32 v2, 3, v1
    ds_read_b64 v[4:5], v2 offset:1024
    s_waitcnt lgkmcnt(0)
    v_mov_b32 v6, v4
    s_nop 1
    v_max_f32_dpp v6, v6, v6 row_ror:4 row_mask:0xf bank_mask:0xf
    s_nop 1
    v_max_f32_dpp v6, v6, v6 row_ror:2 row_mask:0xf bank_mask:0xf
    s_nop 1
    v_max_f32_dpp v6, v6, v6 row_ror:1 row_mask:0xf bank_mask:0xf
    v_sub_f32 v8, v4, v6
    v_max_f32 v8, 0xc3480000, v8
    v_mul_f32 v9, 0x3fb8aa3b, v8
    v_fma_f32 v10, v8, s94, -v9
    v_fmac_f32 v10, 0x32a57060, v8
    v_exp_f32 v9, v9
    v_mul_f32 v10, 0x3f317218, v10
    v_fma_f32 v7, v9, v10, v9

    v_mul_f32 v7, v7, v5
    s_nop 1
    v_add_f32_dpp v7, v7, v7 row_ror:4 row_mask:0xf bank_mask:0xf
    s_nop 1
    v_add_f32_dpp v7, v7, v7 row_ror:2 row_mask:0xf bank_mask:0xf
    s_nop 1
    v_add_f32_dpp v7, v7, v7 row_ror:1 row_mask:0xf bank_mask:0xf
    v_min_u32 v6, -2, v6
    v_min_u32 v7, -2, v7
    s_lshl_b32 s22, s6, 7
    s_add_u32 s22, s22, 262144
    v_readfirstlane_b32 s24, v6
    v_readfirstlane_b32 s25, v7
    s_lshl_b32 s23, s7, 10
    s_add_u32 s23, s23, 262144
    s_nop 2
    s_atomic_swap_x2 s[24:25], s[74:75], s22
    s_mov_b32 s95, 0
L_A0_sp:

    s_load_dwordx2 s[76:77], s[74:75], s23 offset:0 glc
    s_load_dwordx2 s[78:79], s[74:75], s23 offset:128 glc
    s_load_dwordx2 s[80:81], s[74:75], s23 offset:256 glc
    s_load_dwordx2 s[82:83], s[74:75], s23 offset:384 glc
    s_load_dwordx2 s[84:85], s[74:75], s23 offset:512 glc
    s_load_dwordx2 s[86:87], s[74:75], s23 offset:640 glc
    s_load_dwordx2 s[88:89], s[74:75], s23 offset:768 glc
    s_load_dwordx2 s[90:91], s[74:75], s23 offset:896 glc
    s_waitcnt lgkmcnt(0)
    s_max_u32 s26, s76, s77
    s_max_u32 s26, s26, s78
    s_max_u32 s26, s26, s79
    s_max_u32 s26, s26, s80
    s_max_u32 s26, s26, s81
    s_max_u32 s26, s26, s82
    s_max_u32 s26, s26, s83
    s_max_u32 s26, s26, s84
    s_max_u32 s26, s26, s85
    s_max_u32 s26, s26, s86
    s_max_u32 s26, s26, s87
    s_max_u32 s26, s26, s88
    s_max_u32 s26, s26, s89
    s_max_u32 s26, s26, s90
    s_max_u32 s26, s26, s91
    s_cmp_lg_u32 s26, -1
    s_cbranch_scc1 L_A0_spd
    s_add_u32 s95, s95, 1
    s_cmp_lt_u32 s95, 0x10000
    s_cbranch_scc1 L_A0_sp
L_A0_spd:

    v_writelane_b32 v4, s76, 0
    v_writelane_b32 v4, s76, 8
    v_writelane_b32 v5, s77, 0
    v_writelane_b32 v5, s77, 8
    v_writelane_b32 v4, s78, 1
    v_writelane_b32 v4, s78, 9
    v_writelane_b32 v5, s79, 1
    v_writelane_b32 v5, s79, 9
    v_writelane_b32 v4, s80, 2
    v_writelane_b32 v4, s80, 10
    v_writelane_b32 v5, s81, 2
    v_writelane_b32 v5, s81, 10
    v_writelane_b32 v4, s82, 3
    v_writelane_b32 v4, s82, 11
    v_writelane_b32 v5, s83, 3
    v_writelane_b32 v5, s83, 11
    v_writelane_b32 v4, s84, 4
    v_writelane_b32 v4, s84, 12
    v_writelane_b32 v5, s85, 4
    v_writelane_b32 v5, s85, 12
    v_writelane_b32 v4, s86, 5
    v_writelane_b32 v4, s86, 13
    v_writelane_b32 v5, s87, 5
    v_writelane_b32 v5, s87, 13
    v_writelane_b32 v4, s88, 6
    v_writelane_b32 v4, s88, 14
    v_writelane_b32 v5, s89, 6
    v_writelane_b32 v5, s89, 14
    v_writelane_b32 v4, s90, 7
    v_writelane_b32 v4, s90, 15
    v_writelane_b32 v5, s91, 7
    v_writelane_b32 v5, s91, 15
    v_mov_b32 v6, v4
    s_nop 1
    v_max_f32_dpp v6, v6, v6 row_ror:4 row_mask:0xf bank_mask:0xf
    s_nop 1
    v_max_f32_dpp v6, v6, v6 row_ror:2 row_mask:0xf bank_mask:0xf
    s_nop 1
    v_max_f32_dpp v6, v6, v6 row_ror:1 row_mask:0xf bank_mask:0xf
    v_sub_f32 v8, v4, v6
    v_max_f32 v8, 0xc3480000, v8
    v_mul_f32 v9, 0x3fb8aa3b, v8
    v_fma_f32 v10, v8, s94, -v9
    v_fmac_f32 v10, 0x32a57060, v8
    v_exp_f32 v9, v9
    v_mul_f32 v10, 0x3f317218, v10
    v_fma_f32 v7, v9, v10, v9

    v_mul_f32 v7, v7, v5
    s_nop 1
    v_add_f32_dpp v7, v7, v7 row_ror:4 row_mask:0xf bank_mask:0xf
    s_nop 1
    v_add_f32_dpp v7, v7, v7 row_ror:2 row_mask:0xf bank_mask:0xf
    s_nop 1
    v_add_f32_dpp v7, v7, v7 row_ror:1 row_mask:0xf bank_mask:0xf
    v_mov_b32 v2, 1152
    s_mov_b64 exec, 1
    ds_write_b64 v2, v[6:7]
    s_mov_b64 exec, -1
    s_waitcnt lgkmcnt(0)
    v_mov_b32 v10, 8
    v_mov_b32 v9, 1
    ds_write_b32 v10, v9
    s_branch L_TAIL
L_A1:
    s_setprio 0
    s_mov_b32 s8, s54
    s_mov_b32 s9, s55
    s_mov_b32 s10, 7864320
    s_mov_b32 s11, 0x20000
    s_mov_b32 s12, s48
    s_mov_b32 s13, s49
    s_mov_b32 s14, 1280
    s_mov_b32 s15, 0x20000
    v_lshlrev_b32 v4, 2, v0
    buffer_load_dword v20, v4, s[12:15], 0 offen
    buffer_load_dword v21, v4, s[12:15], 0 offen offset:256
    buffer_load_dword v22, v4, s[12:15], 0 offen offset:512
    buffer_load_dword v23, v4, s[12:15], 0 offen offset:768
    buffer_load_dword v24, v4, s[12:15], 0 offen offset:1024
    v_min_u32 v1, 19, v0
    v_lshlrev_b32 v4, 3, v1
    s_mul_i32 s20, s46, 160
    buffer_load_dwordx2 v[26:27], v4, s[12:15], s20 offen

    v_lshrrev_b32 v4, 4, v0
    v_and_b32 v5, 15, v0
    v_mul_u32_u24 v2, 12288, v4
    v_lshl_add_u32 v2, v5, 4, v2
    v_bfe_u32 v5, v0, 3, 1
    v_lshl_add_u32 v3, v5, 2, v4
    v_mul_u32_u24 v3, 12288, v3
    v_and_b32 v5, 7, v0
    v_lshl_add_u32 v3, v5, 4, v3
    v_add_u32 v3, 256, v3

    s_barrier
    s_mul_i32 s20, s46, 983040
    s_mul_i32 s21, s7, 384
    s_add_u32 s20, s20, s21
    s_add_u32 s21, s20, 0
    s_add_u32 s22, s20, 49152
    buffer_load_dwordx4 v[40:43], v2, s[8:11], s21 offen nt
    buffer_load_dwordx4 v[44:47], v2, s[8:11], s22 offen nt
    buffer_load_dwordx4 v[48:51], v3, s[8:11], s21 offen nt
    s_add_u32 s21, s20, 98304
    s_add_u32 s22, s20, 147456
    buffer_load_dwordx4 v[52:55], v2, s[8:11], s21 offen nt
    buffer_load_dwordx4 v[56:59], v2, s[8:11], s22 offen nt
    buffer_load_dwordx4 v[60:63], v3, s[8:11], s21 offen nt
    s_add_u32 s21, s20, 196608
    s_add_u32 s22, s20, 245760
    buffer_load_dwordx4 v[64:67], v2, s[8:11], s21 offen nt
    buffer_load_dwordx4 v[68:71], v2, s[8:11], s22 offen nt
    buffer_load_dwordx4 v[72:75], v3, s[8:11], s21 offen nt
    s_add_u32 s21, s20, 294912
    s_add_u32 s22, s20, 344064
    buffer_load_dwordx4 v[76:79], v2, s[8:11], s21 offen nt
    buffer_load_dwordx4 v[80:83], v2, s[8:11], s22 offen nt
    buffer_load_dwordx4 v[84:87], v3, s[8:11], s21 offen nt
    s_add_u32 s21, s20, 393216
    s_add_u32 s22, s20, 442368
    buffer_load_dwordx4 v[88:91], v2, s[8:11], s21 offen nt
    buffer_load_dwordx4 v[92:95], v2, s[8:11], s22 offen nt
    buffer_load_dwordx4 v[96:99], v3, s[8:11], s21 offen nt
    s_add_u32 s21, s20, 491520
    s_add_u32 s22, s20, 540672
    buffer_load_dwordx4 v[100:103], v2, s[8:11], s21 offen nt
    buffer_load_dwordx4 v[104:107], v2, s[8:11], s22 offen nt
    buffer_load_dwordx4 v[108:111], v3, s[8:11], s21 offen nt
    s_add_u32 s21, s20, 589824
    s_add_u32 s22, s20, 638976
    buffer_load_dwordx4 v[112:115], v2, s[8:11], s21 offen nt
    buffer_load_dwordx4 v[116:119], v2, s[8:11], s22 offen nt
    buffer_load_dwordx4 v[120:123], v3, s[8:11], s21 offen nt
    s_add_u32 s21, s20, 688128
    s_add_u32 s22, s20, 737280
    buffer_load_dwordx4 v[124:127], v2, s[8:11], s21 offen nt
    buffer_load_dwordx4 v[128:131], v2, s[8:11], s22 offen nt
    buffer_load_dwordx4 v[132:135], v3, s[8:11], s21 offen nt
    s_add_u32 s21, s20, 786432
    s_add_u32 s22, s20, 835584
    buffer_load_dwordx4 v[136:139], v2, s[8:11], s21 offen nt
    buffer_load_dwordx4 v[140:143], v2, s[8:11], s22 offen nt
    buffer_load_dwordx4 v[144:147], v3, s[8:11], s21 offen nt
    s_add_u32 s21, s20, 884736
    s_add_u32 s22, s20, 933888
    buffer_load_dwordx4 v[148:151], v2, s[8:11], s21 offen nt
    buffer_load_dwordx4 v[152:155], v2, s[8:11], s22 offen nt
    buffer_load_dwordx4 v[156:159], v3, s[8:11], s21 offen nt
    s_setprio 2
    s_waitcnt vmcnt(30)
    v_lshlrev_b32 v28, 16, v20
    v_and_b32 v29, 0xffff0000, v20
    v_lshlrev_b32 v30, 16, v21
    v_and_b32 v31, 0xffff0000, v21
    v_lshlrev_b32 v32, 16, v22
    v_and_b32 v33, 0xffff0000, v22
    v_lshlrev_b32 v34, 16, v23
    v_and_b32 v35, 0xffff0000, v23
    v_lshlrev_b32 v36, 16, v24
    v_and_b32 v37, 0xffff0000, v24
    v_add_f32 v38, v28, v29
    v_add_f32 v38, v38, v30
    v_add_f32 v38, v38, v31
    v_add_f32 v38, v38, v32
    v_add_f32 v38, v38, v33
    v_add_f32 v38, v38, v34
    v_add_f32 v38, v38, v35
    v_add_f32 v38, v38, v36
    v_add_f32 v38, v38, v37
    s_nop 1
    v_add_f32_dpp v38, v38, v38 row_ror:8 row_mask:0xf bank_mask:0xf
    s_nop 1
    v_add_f32_dpp v38, v38, v38 row_ror:4 row_mask:0xf bank_mask:0xf
    s_nop 1
    v_add_f32_dpp v38, v38, v38 row_ror:2 row_mask:0xf bank_mask:0xf
    s_nop 1
    v_add_f32_dpp v38, v38, v38 row_ror:1 row_mask:0xf bank_mask:0xf
    v_mov_b32 v4, v38
    s_nop 1
    v_permlane16_swap_b32 v38, v4
    v_add_f32 v38, v38, v4
    v_mov_b32 v4, v38
    s_nop 1
    v_permlane32_swap_b32 v38, v4
    v_add_f32 v38, v38, v4
    v_mul_f32 v38, 0x3acccccd, v38
    v_sub_f32 v4, v28, v38
    v_mul_f32 v39, v4, v4
    v_sub_f32 v4, v29, v38
    v_fmac_f32 v39, v4, v4
    v_sub_f32 v4, v30, v38
    v_fmac_f32 v39, v4, v4
    v_sub_f32 v4, v31, v38
    v_fmac_f32 v39, v4, v4
    v_sub_f32 v4, v32, v38
    v_fmac_f32 v39, v4, v4
    v_sub_f32 v4, v33, v38
    v_fmac_f32 v39, v4, v4
    v_sub_f32 v4, v34, v38
    v_fmac_f32 v39, v4, v4
    v_sub_f32 v4, v35, v38
    v_fmac_f32 v39, v4, v4
    v_sub_f32 v4, v36, v38
    v_fmac_f32 v39, v4, v4
    v_sub_f32 v4, v37, v38
    v_fmac_f32 v39, v4, v4
    s_nop 1
    v_add_f32_dpp v39, v39, v39 row_ror:8 row_mask:0xf bank_mask:0xf
    s_nop 1
    v_add_f32_dpp v39, v39, v39 row_ror:4 row_mask:0xf bank_mask:0xf
    s_nop 1
    v_add_f32_dpp v39, v39, v39 row_ror:2 row_mask:0xf bank_mask:0xf
    s_nop 1
    v_add_f32_dpp v39, v39, v39 row_ror:1 row_mask:0xf bank_mask:0xf
    v_mov_b32 v4, v39
    s_nop 1
    v_permlane16_swap_b32 v39, v4
    v_add_f32 v39, v39, v4
    v_mov_b32 v4, v39
    s_nop 1
    v_permlane32_swap_b32 v39, v4
    v_add_f32 v39, v39, v4
    v_mul_f32 v39, 0x3acccccd, v39
    v_cvt_pk_bf16_f32 v39, v39, v39
    v_and_b32 v39, 0xffff0000, v39
    v_add_f32 v39, 0x3727c5ac, v39
    v_cvt_pk_bf16_f32 v39, v39, v39
    v_and_b32 v39, 0xffff0000, v39
    v_sqrt_f32 v39, v39
    s_nop 0
    v_cvt_pk_bf16_f32 v39, v39, v39
    v_and_b32 v39, 0xffff0000, v39
    v_cvt_pk_bf16_f32 v38, v38, v38
    v_and_b32 v38, 0xffff0000, v38
    v_lshlrev_b32 v28, 16, v26
    v_and_b32 v29, 0xffff0000, v26
    v_lshlrev_b32 v30, 16, v27
    v_and_b32 v31, 0xffff0000, v27
    v_rcp_f32 v32, v39

    v_sub_f32 v28, v28, v38
    v_cvt_pk_bf16_f32 v28, v28, v28
    v_and_b32 v28, 0xffff0000, v28
    v_mul_f32 v33, v28, v32
    v_fma_f32 v34, -v33, v39, v28
    v_fma_f32 v28, v34, v32, v33
    v_cvt_pk_bf16_f32 v28, v28, v28
    v_and_b32 v28, 0xffff0000, v28
    v_sub_f32 v29, v29, v38
    v_cvt_pk_bf16_f32 v29, v29, v29
    v_and_b32 v29, 0xffff0000, v29
    v_mul_f32 v33, v29, v32
    v_fma_f32 v34, -v33, v39, v29
    v_fma_f32 v29, v34, v32, v33
    v_cvt_pk_bf16_f32 v29, v29, v29
    v_and_b32 v29, 0xffff0000, v29
    v_sub_f32 v30, v30, v38
    v_cvt_pk_bf16_f32 v30, v30, v30
    v_and_b32 v30, 0xffff0000, v30
    v_mul_f32 v33, v30, v32
    v_fma_f32 v34, -v33, v39, v30
    v_fma_f32 v30, v34, v32, v33
    v_cvt_pk_bf16_f32 v30, v30, v30
    v_and_b32 v30, 0xffff0000, v30
    v_sub_f32 v31, v31, v38
    v_cvt_pk_bf16_f32 v31, v31, v31
    v_and_b32 v31, 0xffff0000, v31
    v_mul_f32 v33, v31, v32
    v_fma_f32 v34, -v33, v39, v31
    v_fma_f32 v31, v34, v32, v33
    v_cvt_pk_bf16_f32 v31, v31, v31
    v_and_b32 v31, 0xffff0000, v31
    v_lshrrev_b32 v35, 4, v0
    v_bfe_u32 v33, v0, 3, 1
    v_lshl_add_u32 v35, v33, 2, v35
    v_lshlrev_b32 v35, 2, v35
    v_add_u32 v35, 5120, v35

    v_and_b32 v33, 15, v0
    v_lshrrev_b32 v34, 4, v0
    v_lshlrev_b32 v36, 5, v33
    v_lshl_add_u32 v36, v34, 4, v36
    v_add_u32 v33, 224, v36
    v_cmp_gt_u32 vcc, 32, v0
    v_mov_b32 v34, 2147483632
    s_nop 0
    v_cndmask_b32 v36, v33, v36, vcc
    v_and_b32 v33, 40, v0
    v_cmp_eq_u32 vcc, 32, v33
    s_nop 1
    v_cndmask_b32 v36, v36, v34, vcc

    v_mov_b32 v5, 12
    s_mov_b32 s95, 0
SP_21:
    ds_read_b32 v4, v5
    s_waitcnt lgkmcnt(0)
    v_readfirstlane_b32 s93, v4
    s_cmp_lg_u32 s93, 0
    s_cbranch_scc1 SPD_22
    s_sleep 4
    s_add_u32 s95, s95, 1
    s_cmp_lt_u32 s95, 0x40000
    s_cbranch_scc1 SP_21
SPD_22:
    s_and_b32 s45, s93, 3
    s_mul_i32 s20, s46, 320
    s_add_u32 s20, s20, 0
    s_add_u32 s21, s20, 15360
    s_add_u32 s22, s20, 30720
    s_add_u32 s23, s20, 46080
    v_lshlrev_b32 v2, 4, v1

    s_mov_b32 s95, 0
PL_23:
    buffer_load_dwordx4 v[4:7], v2, s[16:19], s20 offen sc1
    buffer_load_dwordx4 v[20:23], v2, s[16:19], s20 offen offset:2560 sc1
    buffer_load_dwordx4 v[8:11], v2, s[16:19], s21 offen sc1
    buffer_load_dwordx4 v[24:27], v2, s[16:19], s21 offen offset:2560 sc1
    buffer_load_dwordx4 v[12:15], v2, s[16:19], s22 offen sc1
    buffer_load_dwordx4 v[160:163], v2, s[16:19], s22 offen offset:2560 sc1
    buffer_load_dwordx4 v[16:19], v2, s[16:19], s23 offen sc1
    buffer_load_dwordx4 v[164:167], v2, s[16:19], s23 offen offset:2560 sc1
    s_waitcnt vmcnt(0)
    v_max3_u32 v33, v4, v5, v6
    v_max3_u32 v33, v33, v7, v8
    v_max3_u32 v33, v33, v9, v10
    v_max3_u32 v33, v33, v11, v12
    v_max3_u32 v33, v33, v13, v14
    v_max3_u32 v33, v33, v15, v16
    v_max3_u32 v33, v33, v17, v18
    v_max3_u32 v33, v33, v19, v20
    v_max3_u32 v33, v33, v21, v22
    v_max3_u32 v33, v33, v23, v24
    v_max3_u32 v33, v33, v25, v26
    v_max3_u32 v33, v33, v27, v160
    v_max3_u32 v33, v33, v161, v162
    v_max3_u32 v33, v33, v163, v164
    v_max3_u32 v33, v33, v165, v166
    v_max_u32 v33, v33, v167
    v_cmp_eq_u32 vcc, -1, v33
    s_cbranch_vccz PD_24
    s_sleep 2
    s_add_u32 s95, s95, 1
    s_cmp_lt_u32 s95, 0x10000
    s_cbranch_scc1 PL_23
PD_24:
    v_pk_add_f32 v[4:5], v[4:5], v[8:9]
    v_pk_add_f32 v[12:13], v[12:13], v[16:17]
    v_pk_add_f32 v[20:21], v[20:21], v[24:25]
    v_pk_add_f32 v[160:161], v[160:161], v[164:165]
    v_pk_add_f32 v[4:5], v[4:5], v[12:13]
    v_pk_add_f32 v[20:21], v[20:21], v[160:161]

    v_pk_add_f32 v[6:7], v[6:7], v[10:11]
    v_pk_add_f32 v[14:15], v[14:15], v[18:19]
    v_pk_add_f32 v[22:23], v[22:23], v[26:27]
    v_pk_add_f32 v[162:163], v[162:163], v[166:167]
    v_pk_add_f32 v[6:7], v[6:7], v[14:15]
    v_pk_add_f32 v[22:23], v[22:23], v[162:163]

    v_cvt_pk_bf16_f32 v4, v4, v4
    v_and_b32 v4, 0xffff0000, v4
    v_cvt_pk_bf16_f32 v20, v20, v20
    v_and_b32 v20, 0xffff0000, v20
    v_add_f32 v20, 1.0, v20
    v_cvt_pk_bf16_f32 v20, v20, v20
    v_and_b32 v20, 0xffff0000, v20
    v_mul_f32 v28, v28, v20
    v_cvt_pk_bf16_f32 v28, v28, v28
    v_and_b32 v28, 0xffff0000, v28
    v_add_f32 v28, v28, v4
    v_cvt_pk_bf16_f32 v28, v28, v28
    v_cvt_pk_bf16_f32 v5, v5, v5
    v_and_b32 v5, 0xffff0000, v5
    v_cvt_pk_bf16_f32 v21, v21, v21
    v_and_b32 v21, 0xffff0000, v21
    v_add_f32 v21, 1.0, v21
    v_cvt_pk_bf16_f32 v21, v21, v21
    v_and_b32 v21, 0xffff0000, v21
    v_mul_f32 v29, v29, v21
    v_cvt_pk_bf16_f32 v29, v29, v29
    v_and_b32 v29, 0xffff0000, v29
    v_add_f32 v29, v29, v5
    v_cvt_pk_bf16_f32 v29, v29, v29
    v_cvt_pk_bf16_f32 v6, v6, v6
    v_and_b32 v6, 0xffff0000, v6
    v_cvt_pk_bf16_f32 v22, v22, v22
    v_and_b32 v22, 0xffff0000, v22
    v_add_f32 v22, 1.0, v22
    v_cvt_pk_bf16_f32 v22, v22, v22
    v_and_b32 v22, 0xffff0000, v22
    v_mul_f32 v30, v30, v22
    v_cvt_pk_bf16_f32 v30, v30, v30
    v_and_b32 v30, 0xffff0000, v30
    v_add_f32 v30, v30, v6
    v_cvt_pk_bf16_f32 v30, v30, v30
    v_cvt_pk_bf16_f32 v7, v7, v7
    v_and_b32 v7, 0xffff0000, v7
    v_cvt_pk_bf16_f32 v23, v23, v23
    v_and_b32 v23, 0xffff0000, v23
    v_add_f32 v23, 1.0, v23
    v_cvt_pk_bf16_f32 v23, v23, v23
    v_and_b32 v23, 0xffff0000, v23
    v_mul_f32 v31, v31, v23
    v_cvt_pk_bf16_f32 v31, v31, v31
    v_and_b32 v31, 0xffff0000, v31
    v_add_f32 v31, v31, v7
    v_cvt_pk_bf16_f32 v31, v31, v31
    ds_write_b128 v2, v[28:31] offset:5120
    v_and_b32 v33, 1, v0
    v_lshlrev_b32 v33, 4, v33
    v_mov_b32 v34, 0xffff
    v_lshlrev_b32 v33, v33, v34
    v_bfe_u32 v34, v0, 1, 2

    v_cmp_eq_u32 vcc, 0, v34
    s_nop 1
    v_cndmask_b32 v16, 0, v33, vcc
    v_cmp_eq_u32 vcc, 1, v34
    s_nop 1
    v_cndmask_b32 v17, 0, v33, vcc
    v_cmp_eq_u32 vcc, 2, v34
    s_nop 1
    v_cndmask_b32 v18, 0, v33, vcc
    v_cmp_eq_u32 vcc, 3, v34
    s_nop 1
    v_cndmask_b32 v19, 0, v33, vcc
    s_waitcnt lgkmcnt(0)
    ds_read_b32 v2, v35 offset:0
    ds_read_b32 v3, v35 offset:32
    s_waitcnt lgkmcnt(1)
    v_and_b32 v20, v2, v16
    v_and_b32 v21, v2, v17
    v_and_b32 v22, v2, v18
    v_and_b32 v23, v2, v19
    ds_read_b32 v2, v35 offset:64
    s_nop 0
    v_mfma_f32_16x16x32_bf16 v[4:7], v[20:23], v[40:43], 0
    v_mfma_f32_16x16x32_bf16 v[8:11], v[20:23], v[44:47], 0
    v_mfma_f32_16x16x32_bf16 v[12:15], v[20:23], v[48:51], 0
    s_waitcnt lgkmcnt(1)
    v_and_b32 v24, v3, v16
    v_and_b32 v25, v3, v17
    v_and_b32 v26, v3, v18
    v_and_b32 v27, v3, v19
    ds_read_b32 v3, v35 offset:96
    s_nop 0
    v_mfma_f32_16x16x32_bf16 v[4:7], v[24:27], v[52:55], v[4:7]
    v_mfma_f32_16x16x32_bf16 v[8:11], v[24:27], v[56:59], v[8:11]
    v_mfma_f32_16x16x32_bf16 v[12:15], v[24:27], v[60:63], v[12:15]
    s_waitcnt lgkmcnt(1)
    v_and_b32 v20, v2, v16
    v_and_b32 v21, v2, v17
    v_and_b32 v22, v2, v18
    v_and_b32 v23, v2, v19
    ds_read_b32 v2, v35 offset:128
    s_nop 0
    v_mfma_f32_16x16x32_bf16 v[4:7], v[20:23], v[64:67], v[4:7]
    v_mfma_f32_16x16x32_bf16 v[8:11], v[20:23], v[68:71], v[8:11]
    v_mfma_f32_16x16x32_bf16 v[12:15], v[20:23], v[72:75], v[12:15]
    s_waitcnt lgkmcnt(1)
    v_and_b32 v24, v3, v16
    v_and_b32 v25, v3, v17
    v_and_b32 v26, v3, v18
    v_and_b32 v27, v3, v19
    ds_read_b32 v3, v35 offset:160
    s_nop 0
    v_mfma_f32_16x16x32_bf16 v[4:7], v[24:27], v[76:79], v[4:7]
    v_mfma_f32_16x16x32_bf16 v[8:11], v[24:27], v[80:83], v[8:11]
    v_mfma_f32_16x16x32_bf16 v[12:15], v[24:27], v[84:87], v[12:15]
    s_waitcnt lgkmcnt(1)
    v_and_b32 v20, v2, v16
    v_and_b32 v21, v2, v17
    v_and_b32 v22, v2, v18
    v_and_b32 v23, v2, v19
    ds_read_b32 v2, v35 offset:192
    s_nop 0
    v_mfma_f32_16x16x32_bf16 v[4:7], v[20:23], v[88:91], v[4:7]
    v_mfma_f32_16x16x32_bf16 v[8:11], v[20:23], v[92:95], v[8:11]
    v_mfma_f32_16x16x32_bf16 v[12:15], v[20:23], v[96:99], v[12:15]
    s_waitcnt lgkmcnt(1)
    v_and_b32 v24, v3, v16
    v_and_b32 v25, v3, v17
    v_and_b32 v26, v3, v18
    v_and_b32 v27, v3, v19
    ds_read_b32 v3, v35 offset:224
    s_nop 0
    v_mfma_f32_16x16x32_bf16 v[4:7], v[24:27], v[100:103], v[4:7]
    v_mfma_f32_16x16x32_bf16 v[8:11], v[24:27], v[104:107], v[8:11]
    v_mfma_f32_16x16x32_bf16 v[12:15], v[24:27], v[108:111], v[12:15]
    s_waitcnt lgkmcnt(1)
    v_and_b32 v20, v2, v16
    v_and_b32 v21, v2, v17
    v_and_b32 v22, v2, v18
    v_and_b32 v23, v2, v19
    ds_read_b32 v2, v35 offset:256
    s_nop 0
    v_mfma_f32_16x16x32_bf16 v[4:7], v[20:23], v[112:115], v[4:7]
    v_mfma_f32_16x16x32_bf16 v[8:11], v[20:23], v[116:119], v[8:11]
    v_mfma_f32_16x16x32_bf16 v[12:15], v[20:23], v[120:123], v[12:15]
    s_waitcnt lgkmcnt(1)
    v_and_b32 v24, v3, v16
    v_and_b32 v25, v3, v17
    v_and_b32 v26, v3, v18
    v_and_b32 v27, v3, v19
    ds_read_b32 v3, v35 offset:288
    s_nop 0
    v_mfma_f32_16x16x32_bf16 v[4:7], v[24:27], v[124:127], v[4:7]
    v_mfma_f32_16x16x32_bf16 v[8:11], v[24:27], v[128:131], v[8:11]
    v_mfma_f32_16x16x32_bf16 v[12:15], v[24:27], v[132:135], v[12:15]
    s_waitcnt lgkmcnt(1)
    v_and_b32 v20, v2, v16
    v_and_b32 v21, v2, v17
    v_and_b32 v22, v2, v18
    v_and_b32 v23, v2, v19
    s_nop 0
    s_nop 0
    v_mfma_f32_16x16x32_bf16 v[4:7], v[20:23], v[136:139], v[4:7]
    v_mfma_f32_16x16x32_bf16 v[8:11], v[20:23], v[140:143], v[8:11]
    v_mfma_f32_16x16x32_bf16 v[12:15], v[20:23], v[144:147], v[12:15]
    s_waitcnt lgkmcnt(0)
    v_and_b32 v24, v3, v16
    v_and_b32 v25, v3, v17
    v_and_b32 v26, v3, v18
    v_and_b32 v27, v3, v19
    s_nop 0
    s_nop 0
    v_mfma_f32_16x16x32_bf16 v[4:7], v[24:27], v[148:151], v[4:7]
    v_mfma_f32_16x16x32_bf16 v[8:11], v[24:27], v[152:155], v[8:11]
    v_mfma_f32_16x16x32_bf16 v[12:15], v[24:27], v[156:159], v[12:15]
    s_mul_i32 s21, s6, 768
    s_add_u32 s21, s21, 65536
    s_nop 7
    v_permlane32_swap_b32 v8, v12
    v_permlane32_swap_b32 v9, v13
    v_permlane32_swap_b32 v10, v14
    v_permlane32_swap_b32 v11, v15
    v_add_f32 v4, v4, v12
    v_add_f32 v5, v5, v13
    v_add_f32 v6, v6, v14
    v_add_f32 v7, v7, v15
    v_add_f32_dpp v4, v8, v12 row_ror:8 row_mask:0xc bank_mask:0xf
    v_add_f32_dpp v5, v9, v13 row_ror:8 row_mask:0xc bank_mask:0xf
    v_add_f32_dpp v6, v10, v14 row_ror:8 row_mask:0xc bank_mask:0xf
    v_add_f32_dpp v7, v11, v15 row_ror:8 row_mask:0xc bank_mask:0xf
    v_min_u32 v4, -2, v4
    v_min_u32 v5, -2, v5
    v_min_u32 v6, -2, v6
    v_min_u32 v7, -2, v7
    s_cmp_eq_u32 s45, 1
    s_cbranch_scc0 SF_25
    buffer_store_dwordx4 v[4:7], v36, s[16:19], s21 offen
SJ_26:
    s_mul_i32 s21, s7, 6144
    s_add_u32 s21, s21, 65536
    s_add_u32 s22, s21, 3072
    v_min_u32 v1, 47, v0
    v_lshlrev_b32 v2, 4, v1

    s_mov_b32 s95, 0
PL_27:
    buffer_load_dwordx4 v[40:43], v2, s[16:19], s21 offen offset:0 sc1
    buffer_load_dwordx4 v[44:47], v2, s[16:19], s21 offen offset:768 sc1
    buffer_load_dwordx4 v[48:51], v2, s[16:19], s21 offen offset:1536 sc1
    buffer_load_dwordx4 v[52:55], v2, s[16:19], s21 offen offset:2304 sc1
    buffer_load_dwordx4 v[56:59], v2, s[16:19], s22 offen offset:0 sc1
    buffer_load_dwordx4 v[60:63], v2, s[16:19], s22 offen offset:768 sc1
    buffer_load_dwordx4 v[64:67], v2, s[16:19], s22 offen offset:1536 sc1
    buffer_load_dwordx4 v[68:71], v2, s[16:19], s22 offen offset:2304 sc1
    s_waitcnt vmcnt(0)
    v_max3_u32 v33, v40, v41, v42
    v_max3_u32 v33, v33, v43, v44
    v_max3_u32 v33, v33, v45, v46
    v_max3_u32 v33, v33, v47, v48
    v_max3_u32 v33, v33, v49, v50
    v_max3_u32 v33, v33, v51, v52
    v_max3_u32 v33, v33, v53, v54
    v_max3_u32 v33, v33, v55, v56
    v_max3_u32 v33, v33, v57, v58
    v_max3_u32 v33, v33, v59, v60
    v_max3_u32 v33, v33, v61, v62
    v_max3_u32 v33, v33, v63, v64
    v_max3_u32 v33, v33, v65, v66
    v_max3_u32 v33, v33, v67, v68
    v_max3_u32 v33, v33, v69, v70
    v_max_u32 v33, v33, v71
    v_cmp_eq_u32 vcc, -1, v33
    s_cbranch_vccz PD_28
    s_sleep 1
    s_add_u32 s95, s95, 1
    s_cmp_lt_u32 s95, 0x10000
    s_cbranch_scc1 PL_27
PD_28:
    v_pk_add_f32 v[40:41], v[40:41], v[44:45]
    v_pk_add_f32 v[48:49], v[48:49], v[52:53]
    v_pk_add_f32 v[56:57], v[56:57], v[60:61]
    v_pk_add_f32 v[64:65], v[64:65], v[68:69]
    v_pk_add_f32 v[40:41], v[40:41], v[48:49]
    v_pk_add_f32 v[56:57], v[56:57], v[64:65]
    v_pk_add_f32 v[40:41], v[40:41], v[56:57]
    v_pk_add_f32 v[42:43], v[42:43], v[46:47]
    v_pk_add_f32 v[50:51], v[50:51], v[54:55]
    v_pk_add_f32 v[58:59], v[58:59], v[62:63]
    v_pk_add_f32 v[66:67], v[66:67], v[70:71]
    v_pk_add_f32 v[42:43], v[42:43], v[50:51]
    v_pk_add_f32 v[58:59], v[58:59], v[66:67]
    v_pk_add_f32 v[42:43], v[42:43], v[58:59]
    v_cvt_pk_bf16_f32 v4, v40, v41
    v_cvt_pk_bf16_f32 v5, v42, v43
    v_lshlrev_b32 v2, 3, v1
    ds_write_b64 v2, v[4:5] offset:256
    s_waitcnt lgkmcnt(0)

    v_mov_b32 v10, 0
    v_mov_b32 v9, 1
    ds_write_b32 v10, v9
    s_branch L_TAIL
L_A2:
    s_setprio 3
    s_mov_b32 s12, s48
    s_mov_b32 s13, s49
    s_mov_b32 s14, 1280
    s_mov_b32 s15, 0x20000
    v_mov_b32 v4, -1
    v_mov_b32 v5, -1
    v_mov_b32 v6, -1
    v_mov_b32 v7, -1
    v_lshlrev_b32 v1, 4, v0
    s_lshl_b32 s20, s6, 7
    s_add_u32 s20, s20, 786432
    s_mov_b32 exec_lo, 0x1
    s_mov_b32 exec_hi, 0x0
    buffer_store_dwordx4 v[4:7], v1, s[16:19], s20 offen sc1
    s_mov_b64 exec, -1
    s_lshl_b32 s20, s6, 7
    s_add_u32 s20, s20, 262144
    s_mov_b32 exec_lo, 0x1
    s_mov_b32 exec_hi, 0x0
    buffer_store_dwordx4 v[4:7], v1, s[16:19], s20 offen sc1
    s_mov_b64 exec, -1
    s_min_u32 s22, s2, 239
    s_and_b32 s20, s22, 3
    s_mul_i32 s20, s20, 15360
    s_lshr_b32 s21, s22, 2
    s_lshl_b32 s21, s21, 8
    s_add_u32 s20, s20, s21
    s_add_u32 s20, s20, 0
    s_cmp_ge_u32 s2, 240
    s_cselect_b32 s20, 2147483632, s20
    s_mov_b32 exec_lo, 0xffff
    s_mov_b32 exec_hi, 0x0
    buffer_store_dwordx4 v[4:7], v1, s[16:19], s20 offen sc1
    s_mov_b64 exec, -1
    s_mul_i32 s77, s5, 26
    s_lshr_b32 s77, s77, 8
    s_mul_i32 s76, s77, 10
    s_sub_u32 s76, s5, s76
    s_mul_i32 s80, s5, 52
    s_lshr_b32 s80, s80, 8
    s_mul_i32 s78, s80, 5
    s_sub_u32 s78, s5, s78
    s_and_b32 s79, s80, 1
    s_lshr_b32 s80, s80, 1

    s_add_u32 s67, s74, 0x3fffff
    s_and_b32 s67, s67, 0xffe00000
    s_sub_u32 s67, s67, s74
    s_lshl_b32 s21, s76, 2
    s_add_u32 s21, s21, 0
    s_lshr_b32 s20, s21, 1
    s_lshl_b32 s20, s20, 14
    s_and_b32 s21, s21, 1
    s_lshl_b32 s21, s21, 7
    s_add_u32 s20, s20, s21
    s_mul_i32 s21, s4, 3
    s_add_u32 s21, s21, s77
    s_lshl_b32 s21, s21, 8
    s_add_u32 s20, s20, s21

    s_add_u32 s20, s20, s67
    s_cmp_ge_u32 s5, 30
    s_cselect_b32 s20, 1073741824, s20
    v_lshrrev_b32 v8, 5, v0
    v_lshlrev_b32 v8, 19, v8
    v_bfe_u32 v9, v0, 4, 1
    v_lshl_add_u32 v8, v9, 13, v8
    v_bfe_u32 v9, v0, 3, 1
    v_lshl_add_u32 v8, v9, 14, v8
    v_bfe_u32 v9, v0, 2, 1
    v_lshl_add_u32 v8, v9, 7, v8
    v_and_b32 v9, 3, v0
    v_lshl_add_u32 v8, v9, 4, v8
    buffer_store_dwordx4 v[4:7], v8, s[16:19], s20 offen sc1

    s_mul_i32 s20, s6, 768
    s_add_u32 s20, s20, 65536
    s_mov_b32 exec_lo, 0xffffffff
    s_mov_b32 exec_hi, 0xffff
    buffer_store_dwordx4 v[4:7], v1, s[16:19], s20 offen
    s_mov_b64 exec, -1
    s_mul_i32 s20, s6, 768
    s_add_u32 s20, s20, 327680
    s_mov_b32 exec_lo, 0xffffffff
    s_mov_b32 exec_hi, 0xffff
    buffer_store_dwordx4 v[4:7], v1, s[16:19], s20 offen
    s_mov_b64 exec, -1
    s_min_u32 s21, s5, 19
    s_mul_i32 s21, s21, 128
    s_mul_i32 s20, s4, 2560
    s_add_u32 s20, s20, s21
    s_add_u32 s20, s20, 589824
    s_mov_b32 exec_lo, 0xff
    s_mov_b32 exec_hi, 0x0
    buffer_store_dwordx4 v[4:7], v1, s[16:19], s20 offen
    s_mov_b64 exec, -1
    s_min_u32 s21, s5, 19
    s_mul_i32 s21, s21, 128
    s_mul_i32 s20, s4, 2560
    s_add_u32 s20, s20, s21
    s_add_u32 s20, s20, 622592
    s_mov_b32 exec_lo, 0xff
    s_mov_b32 exec_hi, 0x0
    buffer_store_dwordx4 v[4:7], v1, s[16:19], s20 offen
    s_mov_b64 exec, -1
    s_min_u32 s21, s5, 29
    s_mul_i32 s21, s21, 256
    s_mul_i32 s20, s4, 7680
    s_add_u32 s20, s20, s21
    s_add_u32 s20, s20, 655360
    s_mov_b32 exec_lo, 0xffff
    s_mov_b32 exec_hi, 0x0
    buffer_store_dwordx4 v[4:7], v1, s[16:19], s20 offen
    s_mov_b64 exec, -1
    s_barrier
    s_getreg_b32 s20, hwreg(HW_REG_XCC_ID)
    s_and_b32 s20, s20, 7
    s_lshl_b32 s22, s20, 3
    s_lshl_b64 s[32:33], 1, s22
    s_lshl_b32 s21, s4, 5
    s_mov_b64 s[34:35], s[32:33]
    s_waitcnt vmcnt(0)
    s_atomic_add_x2 s[34:35], s[72:73], s21 glc

    v_mov_b32 v12, 16
    v_mov_b32 v9, 1
    ds_write_b32 v12, v9
    s_waitcnt lgkmcnt(0)
    s_add_u32 s34, s34, s32
    s_addc_u32 s35, s35, s33
    v_mov_b32 v10, s34
    v_mov_b32 v11, s35
    v_sad_u8 v12, v10, 0, 0
    v_sad_u8 v12, v11, 0, v12
    s_nop 0
    v_readfirstlane_b32 s36, v12

    s_nop 3
    s_cmp_lg_u32 s36, 32
    s_cbranch_scc1 L_A2_mb
    s_or_b32 s34, s34, s35
    s_and_b32 s34, s34, 0xdfdfdfdf
    s_cmp_lg_u32 s34, 0
    s_cselect_b32 s34, 0x10001, 1
    s_mov_b32 s35, s34
    s_atomic_add s35, s[72:73], 0x8 glc
    s_waitcnt lgkmcnt(0)
    s_and_b32 s23, s35, 7
    s_lshl_b32 s23, s23, 8
    s_add_u32 s35, s35, s34

    s_mov_b32 s95, 0
TP_29:
    s_and_b32 s36, s35, 0xffff
    s_cmp_eq_u32 s36, 8
    s_cbranch_scc1 TPD_30
    s_load_dword s35, s[72:73], 0x8 glc
    s_waitcnt lgkmcnt(0)
    s_add_u32 s95, s95, 1
    s_cmp_lt_u32 s95, 0x10000
    s_cbranch_scc1 TP_29

TPD_30:
    s_lshr_b32 s35, s35, 16
    s_cmp_lg_u32 s35, 0
    s_cselect_b32 s35, 2, 1
    s_or_b32 s35, s35, s23
    v_mov_b32 v10, s35
    v_lshlrev_b32 v8, 7, v0
    s_lshl_b32 s20, s4, 12
    s_add_u32 s20, s20, 786432
    s_mov_b32 exec_hi, 0
    buffer_store_dword v10, v8, s[16:19], s20 offen sc1
    s_mov_b64 exec, -1

L_A2_mb:
    s_lshl_b32 s20, s6, 7
    s_add_u32 s20, s20, 786432
    s_mov_b32 s95, 0
MB_31:
    s_load_dword s33, s[74:75], s20 glc
    s_waitcnt lgkmcnt(0)
    s_cmp_lg_u32 s33, -1
    s_cbranch_scc1 MBD_32
    s_add_u32 s95, s95, 1
    s_cmp_lt_u32 s95, 0x10000
    s_cbranch_scc1 MB_31
MBD_32:
    s_and_b32 s97, s33, 0x700
    s_and_b32 s33, s33, 3
    s_cmp_eq_u32 s33, 1
    s_cselect_b32 s45, 1, 2
    s_cmp_eq_u32 s45, 1
    s_cbranch_scc1 L_A2_fast
    s_mul_i32 s20, s6, 768
    s_add_u32 s20, s20, 65536
    s_mov_b32 exec_lo, 0xffffffff
    s_mov_b32 exec_hi, 0xffff
    buffer_store_dwordx4 v[4:7], v1, s[16:19], s20 offen sc1
    s_mov_b64 exec, -1
    s_mul_i32 s20, s6, 768
    s_add_u32 s20, s20, 327680
    s_mov_b32 exec_lo, 0xffffffff
    s_mov_b32 exec_hi, 0xffff
    buffer_store_dwordx4 v[4:7], v1, s[16:19], s20 offen sc1
    s_mov_b64 exec, -1
    s_min_u32 s21, s5, 19
    s_mul_i32 s21, s21, 128
    s_mul_i32 s20, s4, 2560
    s_add_u32 s20, s20, s21
    s_add_u32 s20, s20, 589824
    s_mov_b32 exec_lo, 0xff
    s_mov_b32 exec_hi, 0x0
    buffer_store_dwordx4 v[4:7], v1, s[16:19], s20 offen sc1
    s_mov_b64 exec, -1
    s_min_u32 s21, s5, 19
    s_mul_i32 s21, s21, 128
    s_mul_i32 s20, s4, 2560
    s_add_u32 s20, s20, s21
    s_add_u32 s20, s20, 622592
    s_mov_b32 exec_lo, 0xff
    s_mov_b32 exec_hi, 0x0
    buffer_store_dwordx4 v[4:7], v1, s[16:19], s20 offen sc1
    s_mov_b64 exec, -1
    s_min_u32 s21, s5, 29
    s_mul_i32 s21, s21, 256
    s_mul_i32 s20, s4, 7680
    s_add_u32 s20, s20, s21
    s_add_u32 s20, s20, 655360
    s_mov_b32 exec_lo, 0xffff
    s_mov_b32 exec_hi, 0x0
    buffer_store_dwordx4 v[4:7], v1, s[16:19], s20 offen sc1
    s_mov_b64 exec, -1
    s_mov_b32 s34, 1
    s_lshl_b32 s21, s4, 5
    s_add_u32 s21, s21, 16
    s_waitcnt vmcnt(0)
    s_atomic_add s34, s[72:73], s21 glc
    s_waitcnt lgkmcnt(0)
    s_cmp_lg_u32 s34, 31
    s_cbranch_scc1 L_A2_mb2
    s_mov_b32 s35, 1
    s_atomic_add s35, s[72:73], 0x18 glc
    s_waitcnt lgkmcnt(0)
    s_add_u32 s35, s35, 1

    s_mov_b32 s95, 0
TP_33:
    s_and_b32 s36, s35, 0xffff
    s_cmp_eq_u32 s36, 8
    s_cbranch_scc1 TPD_34
    s_load_dword s35, s[72:73], 0x18 glc
    s_waitcnt lgkmcnt(0)
    s_add_u32 s95, s95, 1
    s_cmp_lt_u32 s95, 0x10000
    s_cbranch_scc1 TP_33

TPD_34:
    s_mov_b32 s35, 1
    v_mov_b32 v10, s35
    v_lshlrev_b32 v8, 7, v0
    s_lshl_b32 s20, s4, 12
    s_add_u32 s20, s20, 786436
    s_mov_b32 exec_hi, 0
    buffer_store_dword v10, v8, s[16:19], s20 offen sc1
    s_mov_b64 exec, -1

L_A2_mb2:
    s_lshl_b32 s20, s6, 7
    s_add_u32 s20, s20, 786436
    s_mov_b32 s95, 0
MB_35:
    s_load_dword s33, s[74:75], s20 glc
    s_waitcnt lgkmcnt(0)
    s_cmp_lg_u32 s33, -1
    s_cbranch_scc1 MBD_36
    s_sleep 2
    s_add_u32 s95, s95, 1
    s_cmp_lt_u32 s95, 0x10000
    s_cbranch_scc1 MB_35
MBD_36:
L_A2_fast:
    s_or_b32 s97, s97, s45
    v_mov_b32 v10, 12
    v_mov_b32 v9, s97
    ds_write_b32 v10, v9
    v_and_b32 v24, 7, v0
    v_lshlrev_b32 v24, 2, v24
    v_bfe_u32 v25, v0, 4, 1
    v_lshl_add_u32 v24, v25, 1, v24
    v_lshrrev_b32 v25, 5, v0
    v_add_u32 v24, v24, v25
    v_and_b32 v27, 8, v0
    v_cmp_eq_u32 vcc, 0, v27
    v_mov_b32 v27, 2147483632
    v_lshlrev_b32 v38, 2, v24
    v_cndmask_b32 v38, v27, v38, vcc
    v_lshlrev_b32 v39, 1, v24
    v_cndmask_b32 v39, v27, v39, vcc
    v_lshrrev_b32 v37, 3, v0
    v_mul_u32_u24 v37, 768, v37
    v_and_b32 v25, 3, v0
    v_lshl_add_u32 v37, v25, 4, v37
    v_bfe_u32 v25, v0, 2, 1
    v_lshl_add_u32 v37, v25, 7, v37

    s_lshr_b32 s68, s5, 8
    s_cmp_ge_u32 s5, 20
    s_cbranch_scc1 L_TAIL
    s_lshl_b32 s20, s5, 7
    s_add_u32 s20, s20, 0
    s_add_u32 s21, s20, 15360
    s_add_u32 s22, s20, 30720
    s_add_u32 s23, s20, 46080
    v_lshlrev_b32 v25, 2, v24
    v_add_u32 v26, 5120, v25
    v_add_u32 v27, 10240, v25
    s_lshl_b32 s32, s5, 6
    v_lshlrev_b32 v28, 1, v24
    buffer_load_ushort v30, v28, s[12:15], s32 offen

    s_mov_b32 s95, 0
PL_37:
    buffer_load_dword v4, v26, s[16:19], s20 offen sc1
    buffer_load_dword v8, v26, s[16:19], s20 offen offset:2560 sc1
    buffer_load_dword v12, v27, s[16:19], s20 offen sc1
    buffer_load_dword v16, v27, s[16:19], s20 offen offset:2560 sc1
    buffer_load_dword v5, v26, s[16:19], s21 offen sc1
    buffer_load_dword v9, v26, s[16:19], s21 offen offset:2560 sc1
    buffer_load_dword v13, v27, s[16:19], s21 offen sc1
    buffer_load_dword v17, v27, s[16:19], s21 offen offset:2560 sc1
    buffer_load_dword v6, v26, s[16:19], s22 offen sc1
    buffer_load_dword v10, v26, s[16:19], s22 offen offset:2560 sc1
    buffer_load_dword v14, v27, s[16:19], s22 offen sc1
    buffer_load_dword v18, v27, s[16:19], s22 offen offset:2560 sc1
    buffer_load_dword v7, v26, s[16:19], s23 offen sc1
    buffer_load_dword v11, v26, s[16:19], s23 offen offset:2560 sc1
    buffer_load_dword v15, v27, s[16:19], s23 offen sc1
    buffer_load_dword v19, v27, s[16:19], s23 offen offset:2560 sc1
    s_waitcnt vmcnt(0)
    v_max3_u32 v20, v4, v5, v6
    v_max3_u32 v20, v20, v7, v8
    v_max3_u32 v20, v20, v9, v10
    v_max3_u32 v20, v20, v11, v12
    v_max3_u32 v20, v20, v13, v14
    v_max3_u32 v20, v20, v15, v16
    v_max3_u32 v20, v20, v17, v18
    v_max_u32 v20, v20, v19
    v_cmp_eq_u32 vcc, -1, v20
    s_cbranch_vccz PD_38
    s_sleep 8
    s_add_u32 s95, s95, 1
    s_cmp_lt_u32 s95, 0x10000
    s_cbranch_scc1 PL_37
PD_38:
    v_add_f32 v4, v4, v5
    v_add_f32 v6, v6, v7
    v_add_f32 v31, v4, v6
    v_cvt_pk_bf16_f32 v31, v31, v31
    v_and_b32 v31, 0xffff0000, v31
    v_add_f32 v8, v8, v9
    v_add_f32 v10, v10, v11
    v_add_f32 v32, v8, v10
    v_cvt_pk_bf16_f32 v32, v32, v32
    v_and_b32 v32, 0xffff0000, v32
    v_add_f32 v12, v12, v13
    v_add_f32 v14, v14, v15
    v_add_f32 v33, v12, v14
    v_cvt_pk_bf16_f32 v33, v33, v33
    v_and_b32 v33, 0xffff0000, v33
    v_add_f32 v16, v16, v17
    v_add_f32 v18, v18, v19
    v_add_f32 v34, v16, v18
    v_cvt_pk_bf16_f32 v34, v34, v34
    v_and_b32 v34, 0xffff0000, v34
    v_add_f32 v33, 1.0, v33
    v_cvt_pk_bf16_f32 v33, v33, v32
    v_min_u32 v33, -2, v33
    v_lshlrev_b32 v30, 16, v30
    s_mul_i32 s21, s4, 2560
    s_lshl_b32 s22, s5, 7
    s_add_u32 s21, s21, s22
    s_add_u32 s21, s21, 622592

    s_cmp_eq_u32 s45, 1
    s_cbranch_scc0 SF_39
    buffer_store_dword v33, v38, s[16:19], s21 offen
SJ_40:
    s_lshl_b32 s20, s5, 14
    s_add_u32 s20, s20, s67
    s_lshl_b32 s21, s4, 7
    s_add_u32 s20, s20, s21
    s_add_u32 s20, s20, 6144
    s_add_u32 s21, s20, 8192
    s_mov_b32 s22, -1
    s_mov_b32 s23, -1
    s_mov_b32 s95, 0
L_A2_ms:
    s_memtime s[24:25]
    s_waitcnt lgkmcnt(0)
    s_load_dword s32, s[74:75], s20 glc
    s_waitcnt lgkmcnt(0)
    s_memtime s[26:27]
    s_waitcnt lgkmcnt(0)
    s_load_dword s32, s[74:75], s21 glc
    s_waitcnt lgkmcnt(0)
    s_memtime s[34:35]
    s_waitcnt lgkmcnt(0)
    s_sub_u32 s24, s26, s24
    s_sub_u32 s26, s34, s26
    s_min_u32 s22, s22, s24
    s_min_u32 s23, s23, s26
    s_add_u32 s95, s95, 1
    s_cmp_lt_u32 s95, 6
    s_cbranch_scc1 L_A2_ms
    s_cmp_lt_u32 s23, s22
    s_cselect_b32 s68, 8192, 0

    s_branch L_TAIL
L_A3:
    s_setprio 2
    s_barrier
    v_mov_b32 v5, 12
    s_mov_b32 s95, 0
SP_41:
    ds_read_b32 v4, v5
    s_waitcnt lgkmcnt(0)
    v_readfirstlane_b32 s93, v4
    s_cmp_lg_u32 s93, 0
    s_cbranch_scc1 SPD_42
    s_sleep 4
    s_add_u32 s95, s95, 1
    s_cmp_lt_u32 s95, 0x40000
    s_cbranch_scc1 SP_41
SPD_42:
    s_and_b32 s45, s93, 3
    s_cmp_ge_u32 s5, 30
    s_cbranch_scc1 L_end
    s_mul_i32 s77, s5, 26
    s_lshr_b32 s77, s77, 8
    s_mul_i32 s76, s77, 10
    s_sub_u32 s76, s5, s76
    s_mul_i32 s80, s5, 52
    s_lshr_b32 s80, s80, 8
    s_mul_i32 s78, s80, 5
    s_sub_u32 s78, s5, s78
    s_and_b32 s79, s80, 1
    s_lshr_b32 s80, s80, 1

    s_mul_i32 s33, s4, 983040
    s_mul_i32 s36, s77, 327680
    s_add_u32 s33, s33, s36
    s_lshl_b32 s36, s76, 7
    s_add_u32 s33, s33, s36
    s_mul_i32 s34, s78, 393216
    s_mul_i32 s35, s4, 384
    s_add_u32 s34, s34, s35
    s_lshl_b32 s35, s80, 7
    s_add_u32 s34, s34, s35
    s_mul_i32 s35, s4, 245760
    s_mul_i32 s36, s77, 81920
    s_add_u32 s35, s35, s36
    s_lshl_b32 s36, s76, 7
    s_add_u32 s35, s35, s36
    s_cmp_ge_u32 s5, 30
    s_cselect_b32 s33, 0x40000000, s33
    s_cselect_b32 s34, 0x40000000, s34
    s_cselect_b32 s35, 0x40000000, s35

    s_mov_b32 s12, s56
    s_mov_b32 s13, s57
    s_mov_b32 s14, 7864320
    s_mov_b32 s15, 0x20000
    v_lshrrev_b32 v3, 3, v0
    v_and_b32 v4, 7, v0
    v_mul_u32_u24 v2, 1280, v3
    v_lshl_add_u32 v2, v4, 4, v2
    s_mov_b32 m0, 16384
    s_add_u32 s36, s33, 0
    buffer_load_dwordx4 v2, s[12:15], s36 offen nt lds
    s_mov_b32 m0, 17408
    s_add_u32 s36, s33, 10240
    buffer_load_dwordx4 v2, s[12:15], s36 offen nt lds
    s_mov_b32 m0, 18432
    s_add_u32 s36, s33, 20480
    buffer_load_dwordx4 v2, s[12:15], s36 offen nt lds
    s_mov_b32 m0, 19456
    s_add_u32 s36, s33, 30720
    buffer_load_dwordx4 v2, s[12:15], s36 offen nt lds
    s_mov_b32 m0, 20480
    s_add_u32 s36, s33, 40960
    buffer_load_dwordx4 v2, s[12:15], s36 offen nt lds
    s_mov_b32 m0, 21504
    s_add_u32 s36, s33, 51200
    buffer_load_dwordx4 v2, s[12:15], s36 offen nt lds
    s_mov_b32 m0, 22528
    s_add_u32 s36, s33, 61440
    buffer_load_dwordx4 v2, s[12:15], s36 offen nt lds
    s_mov_b32 m0, 23552
    s_add_u32 s36, s33, 71680
    buffer_load_dwordx4 v2, s[12:15], s36 offen nt lds
    s_waitcnt vmcnt(7)
    s_mov_b32 m0, 24576
    s_add_u32 s36, s33, 81920
    buffer_load_dwordx4 v2, s[12:15], s36 offen nt lds
    s_waitcnt vmcnt(7)
    s_mov_b32 m0, 25600
    s_add_u32 s36, s33, 92160
    buffer_load_dwordx4 v2, s[12:15], s36 offen nt lds
    s_waitcnt vmcnt(7)
    s_mov_b32 m0, 26624
    s_add_u32 s36, s33, 102400
    buffer_load_dwordx4 v2, s[12:15], s36 offen nt lds
    s_waitcnt vmcnt(7)
    s_mov_b32 m0, 27648
    s_add_u32 s36, s33, 112640
    buffer_load_dwordx4 v2, s[12:15], s36 offen nt lds
    s_waitcnt vmcnt(7)
    s_mov_b32 m0, 28672
    s_add_u32 s36, s33, 122880
    buffer_load_dwordx4 v2, s[12:15], s36 offen nt lds
    s_waitcnt vmcnt(7)
    s_mov_b32 m0, 29696
    s_add_u32 s36, s33, 133120
    buffer_load_dwordx4 v2, s[12:15], s36 offen nt lds
    s_waitcnt vmcnt(7)
    s_mov_b32 m0, 30720
    s_add_u32 s36, s33, 143360
    buffer_load_dwordx4 v2, s[12:15], s36 offen nt lds
    s_waitcnt vmcnt(7)
    s_mov_b32 m0, 31744
    s_add_u32 s36, s33, 153600
    buffer_load_dwordx4 v2, s[12:15], s36 offen nt lds
    s_waitcnt vmcnt(7)
    s_mov_b32 m0, 32768
    s_add_u32 s36, s33, 163840
    buffer_load_dwordx4 v2, s[12:15], s36 offen nt lds
    s_waitcnt vmcnt(7)
    s_mov_b32 m0, 33792
    s_add_u32 s36, s33, 174080
    buffer_load_dwordx4 v2, s[12:15], s36 offen nt lds
    s_waitcnt vmcnt(7)
    s_mov_b32 m0, 34816
    s_add_u32 s36, s33, 184320
    buffer_load_dwordx4 v2, s[12:15], s36 offen nt lds
    s_waitcnt vmcnt(7)
    s_mov_b32 m0, 35840
    s_add_u32 s36, s33, 194560
    buffer_load_dwordx4 v2, s[12:15], s36 offen nt lds
    s_waitcnt vmcnt(7)
    s_mov_b32 m0, 36864
    s_add_u32 s36, s33, 204800
    buffer_load_dwordx4 v2, s[12:15], s36 offen nt lds
    s_waitcnt vmcnt(7)
    s_mov_b32 m0, 37888
    s_add_u32 s36, s33, 215040
    buffer_load_dwordx4 v2, s[12:15], s36 offen nt lds
    s_waitcnt vmcnt(7)
    s_mov_b32 m0, 38912
    s_add_u32 s36, s33, 225280
    buffer_load_dwordx4 v2, s[12:15], s36 offen nt lds
    s_waitcnt vmcnt(7)
    s_mov_b32 m0, 39936
    s_add_u32 s36, s33, 235520
    buffer_load_dwordx4 v2, s[12:15], s36 offen nt lds
    s_waitcnt vmcnt(7)
    s_mov_b32 m0, 40960
    s_add_u32 s36, s33, 245760
    buffer_load_dwordx4 v2, s[12:15], s36 offen nt lds
    s_waitcnt vmcnt(7)
    s_mov_b32 m0, 41984
    s_add_u32 s36, s33, 256000
    buffer_load_dwordx4 v2, s[12:15], s36 offen nt lds
    s_waitcnt vmcnt(7)
    s_mov_b32 m0, 43008
    s_add_u32 s36, s33, 266240
    buffer_load_dwordx4 v2, s[12:15], s36 offen nt lds
    s_waitcnt vmcnt(7)
    s_mov_b32 m0, 44032
    s_add_u32 s36, s33, 276480
    buffer_load_dwordx4 v2, s[12:15], s36 offen nt lds
    s_waitcnt vmcnt(7)
    s_mov_b32 m0, 45056
    s_add_u32 s36, s33, 286720
    buffer_load_dwordx4 v2, s[12:15], s36 offen nt lds
    s_waitcnt vmcnt(7)
    s_mov_b32 m0, 46080
    s_add_u32 s36, s33, 296960
    buffer_load_dwordx4 v2, s[12:15], s36 offen nt lds
    s_waitcnt vmcnt(7)
    s_mov_b32 m0, 47104
    s_add_u32 s36, s33, 307200
    buffer_load_dwordx4 v2, s[12:15], s36 offen nt lds
    s_waitcnt vmcnt(7)
    s_mov_b32 m0, 48128
    s_add_u32 s36, s33, 317440
    buffer_load_dwordx4 v2, s[12:15], s36 offen nt lds
    s_waitcnt vmcnt(0)
    v_mov_b32 v5, 32
    v_mov_b32 v4, 1
    s_mov_b64 exec, 1
    ds_add_u32 v5, v4
    s_mov_b64 exec, -1
L_TAIL:
    s_setprio 1
    s_cmp_ge_u32 s5, 30
    s_cbranch_scc1 L_T_end
    s_sub_u32 s81, s3, 8
    s_mul_i32 s77, s5, 26
    s_lshr_b32 s77, s77, 8
    s_mul_i32 s76, s77, 10
    s_sub_u32 s76, s5, s76
    s_mul_i32 s80, s5, 52
    s_lshr_b32 s80, s80, 8
    s_mul_i32 s78, s80, 5
    s_sub_u32 s78, s5, s78
    s_and_b32 s79, s80, 1
    s_lshr_b32 s80, s80, 1

    s_mov_b32 s28, s70
    s_mov_b32 s29, s71
    s_mov_b32 s30, 1280
    s_mov_b32 s31, 0x20000
    v_and_b32 v24, 7, v0
    v_lshlrev_b32 v24, 2, v24
    v_bfe_u32 v25, v0, 4, 1
    v_lshl_add_u32 v24, v25, 1, v24
    v_lshrrev_b32 v25, 5, v0
    v_add_u32 v24, v24, v25
    v_and_b32 v27, 8, v0
    v_cmp_eq_u32 vcc, 0, v27
    v_mov_b32 v27, 2147483632
    v_lshlrev_b32 v38, 2, v24
    v_cndmask_b32 v38, v27, v38, vcc
    v_lshlrev_b32 v39, 1, v24
    v_cndmask_b32 v39, v27, v39, vcc
    v_lshrrev_b32 v37, 3, v0
    v_mul_u32_u24 v37, 768, v37
    v_and_b32 v25, 3, v0
    v_lshl_add_u32 v37, v25, 4, v37
    v_bfe_u32 v25, v0, 2, 1
    v_lshl_add_u32 v37, v25, 7, v37

    s_add_u32 s67, s74, 0x3fffff
    s_and_b32 s67, s67, 0xffe00000
    s_sub_u32 s67, s67, s74
    s_lshl_b32 s20, s76, 2
    s_add_u32 s20, s20, s81
    s_lshr_b32 s84, s20, 1
    s_lshl_b32 s84, s84, 14
    s_and_b32 s20, s20, 1
    s_lshl_b32 s20, s20, 7
    s_add_u32 s84, s84, s20
    s_mul_i32 s20, s4, 3
    s_add_u32 s20, s20, s77
    s_lshl_b32 s20, s20, 8
    s_add_u32 s84, s84, s20

    s_add_u32 s84, s84, s67
    s_cmp_eq_u32 s81, 2
    s_cselect_b32 s68, s68, 0
    s_lshl_b32 s20, s77, 8
    s_lshl_b32 s21, s81, 6
    s_add_u32 s20, s20, s21
    v_add_u32 v4, s20, v0
    v_mul_u32_u24 v5, 1366, v4
    v_lshrrev_b32 v5, 18, v5
    v_mul_u32_u24 v5, 5376, v5
    v_lshl_add_u32 v96, v4, 2, v5
    s_mul_i32 s82, s4, 24576
    s_add_u32 s82, s82, 327680
    s_add_u32 s83, s82, 4608
    s_lshl_b32 s20, s81, 7
    v_lshl_add_u32 v97, v0, 1, s20
    v_lshrrev_b32 v98, 4, v0
    v_lshlrev_b32 v98, 4, v98
    s_lshl_b32 s20, s81, 8
    v_add_u32 v99, s20, v98
    s_lshl_b32 s21, s81, 7
    v_add_u32 v100, s21, v98
    v_lshl_add_u32 v101, v0, 2, s20
    v_lshl_add_u32 v102, v0, 1, s21
    v_cmp_gt_u32 vcc, 16, v0
    v_mov_b32 v5, 2147483632
    v_lshlrev_b32 v103, 2, v0
    v_cndmask_b32 v104, v5, v103, vcc
    v_lshlrev_b32 v105, 4, v0
    v_lshlrev_b32 v106, 3, v0
    s_lshl_b32 s20, s81, 6
    s_add_u32 s85, s84, 524288
    s_add_u32 s84, s84, 0
    s_add_u32 s53, s84, 8192
    s_add_u32 s54, s85, 8192
    s_mul_i32 s86, s4, 2560
    s_lshl_b32 s21, s78, 9
    s_add_u32 s87, s86, s21
    s_add_u32 s88, s87, 622592
    s_add_u32 s87, s87, 589824
    s_add_u32 s86, s86, 589824
    s_mul_i32 s89, s4, 7680
    s_add_u32 s89, s89, 655360
    s_mul_i32 s48, s79, 5
    s_add_u32 s48, s48, s78
    s_mul_i32 s48, s48, 768
    s_lshl_b32 s21, s80, 8
    s_add_u32 s48, s48, s21
    s_add_u32 s48, s48, s20
    s_add_u32 s48, s48, s89
    s_lshl_b32 s49, s77, 8
    s_add_u32 s49, s49, s89
    s_add_u32 s50, s49, 3840
    s_lshl_b32 s52, s5, 14
    s_add_u32 s52, s52, s67
    s_add_u32 s52, s52, s68
    s_add_u32 s55, s52, 524288
    s_add_u32 s52, s52, 0
    s_lshl_b32 s51, s5, 7
    s_add_u32 s51, s51, s86
    s_mov_b32 s66, s60
    s_lshl_b32 s60, s5, 6
    s_cmp_eq_u32 s81, 2
    s_cselect_b32 s20, 1, 0
    s_cmp_lt_u32 s5, 20
    s_cselect_b32 s21, 1, 0
    s_and_b32 s58, s20, s21
    s_and_b32 s21, s5, 7
    s_cmp_eq_u32 s21, s4
    s_cselect_b32 s21, 1, 0
    s_and_b32 s59, s58, s21
    v_lshrrev_b32 v4, 4, v0
    v_bfe_u32 v5, v0, 2, 2
    v_lshl_add_u32 v4, v4, 3, v5
    v_lshlrev_b32 v4, 7, v4
    v_and_b32 v5, 3, v0
    v_lshl_add_u32 v4, v5, 3, v4
    s_lshl_b32 s20, s81, 5
    v_add_u32 v4, s20, v4
    v_add_u32 v107, 49152, v4
    v_add_u32 v114, 16384, v4
    v_mov_b32 v115, 32
    v_mov_b32 v21, 24
    v_mov_b32 v22, 1

    s_mov_b32 s95, 0
PL_43:
    buffer_load_dwordx2 v[108:109], v106, s[16:19], s88 offen sc1
    s_waitcnt vmcnt(0)
    v_max_u32 v20, v108, v109
    v_cmp_eq_u32 vcc, -1, v20
    s_cbranch_vccz PD_44
    s_sleep 8
    s_add_u32 s95, s95, 1
    s_cmp_lt_u32 s95, 0x10000
    s_cbranch_scc1 PL_43
PD_44:
    v_lshlrev_b32 v110, 16, v108
    v_and_b32 v111, 0xffff0000, v108
    v_lshlrev_b32 v112, 16, v109
    v_and_b32 v113, 0xffff0000, v109

    s_cmp_lg_u32 s81, 3
    s_cbranch_scc1 L_T_nodma
    s_mul_i32 s33, s4, 983040
    s_mul_i32 s36, s77, 327680
    s_add_u32 s33, s33, s36
    s_lshl_b32 s36, s76, 7
    s_add_u32 s33, s33, s36
    s_mul_i32 s34, s78, 393216
    s_mul_i32 s35, s4, 384
    s_add_u32 s34, s34, s35
    s_lshl_b32 s35, s80, 7
    s_add_u32 s34, s34, s35
    s_mul_i32 s35, s4, 245760
    s_mul_i32 s36, s77, 81920
    s_add_u32 s35, s35, s36
    s_lshl_b32 s36, s76, 7
    s_add_u32 s35, s35, s36
    s_cmp_ge_u32 s5, 30
    s_cselect_b32 s33, 0x40000000, s33
    s_cselect_b32 s34, 0x40000000, s34
    s_cselect_b32 s35, 0x40000000, s35

    s_cmp_eq_u32 s79, 0
    s_cselect_b32 s24, s66, s62
    s_cselect_b32 s25, s61, s63
    s_mov_b32 s26, 1966080
    s_mov_b32 s27, 0x20000

    s_mov_b32 s8, s64
    s_mov_b32 s9, s65
    s_mov_b32 s10, 1966080
    s_mov_b32 s11, 0x20000
    v_lshrrev_b32 v6, 3, v0
    v_and_b32 v7, 7, v0
    v_mul_u32_u24 v1, 3072, v6
    v_lshl_add_u32 v1, v7, 4, v1
    v_mul_u32_u24 v2, 1280, v6
    v_lshl_add_u32 v2, v7, 4, v2

    v_mov_b32 v9, 40
    s_mov_b32 s95, 0
SP_45:
    ds_read_b32 v8, v9
    s_waitcnt lgkmcnt(0)
    v_readfirstlane_b32 s93, v8
    s_cmp_eq_u32 s93, 8
    s_cbranch_scc1 SPD_46
    s_sleep 1
    s_add_u32 s95, s95, 1
    s_cmp_lt_u32 s95, 0x40000
    s_cbranch_scc1 SP_45
SPD_46:
    s_mov_b32 m0, 49152
    s_add_u32 s36, s34, 0
    buffer_load_dwordx4 v1, s[24:27], s36 offen nt lds
    s_mov_b32 m0, 50176
    s_add_u32 s36, s34, 24576
    buffer_load_dwordx4 v1, s[24:27], s36 offen nt lds
    s_mov_b32 m0, 51200
    s_add_u32 s36, s34, 49152
    buffer_load_dwordx4 v1, s[24:27], s36 offen nt lds
    s_mov_b32 m0, 52224
    s_add_u32 s36, s34, 73728
    buffer_load_dwordx4 v1, s[24:27], s36 offen nt lds
    s_mov_b32 m0, 53248
    s_add_u32 s36, s34, 98304
    buffer_load_dwordx4 v1, s[24:27], s36 offen nt lds
    s_mov_b32 m0, 54272
    s_add_u32 s36, s34, 122880
    buffer_load_dwordx4 v1, s[24:27], s36 offen nt lds
    s_mov_b32 m0, 55296
    s_add_u32 s36, s34, 147456
    buffer_load_dwordx4 v1, s[24:27], s36 offen nt lds
    s_mov_b32 m0, 56320
    s_add_u32 s36, s34, 172032
    buffer_load_dwordx4 v1, s[24:27], s36 offen nt lds
    s_mov_b32 m0, 57344
    s_add_u32 s36, s34, 196608
    buffer_load_dwordx4 v1, s[24:27], s36 offen nt lds
    s_mov_b32 m0, 58368
    s_add_u32 s36, s34, 221184
    buffer_load_dwordx4 v1, s[24:27], s36 offen nt lds
    s_mov_b32 m0, 59392
    s_add_u32 s36, s34, 245760
    buffer_load_dwordx4 v1, s[24:27], s36 offen nt lds
    s_mov_b32 m0, 60416
    s_add_u32 s36, s34, 270336
    buffer_load_dwordx4 v1, s[24:27], s36 offen nt lds
    s_mov_b32 m0, 61440
    s_add_u32 s36, s34, 294912
    buffer_load_dwordx4 v1, s[24:27], s36 offen nt lds
    s_mov_b32 m0, 62464
    s_add_u32 s36, s34, 319488
    buffer_load_dwordx4 v1, s[24:27], s36 offen nt lds
    s_mov_b32 m0, 63488
    s_add_u32 s36, s34, 344064
    buffer_load_dwordx4 v1, s[24:27], s36 offen nt lds
    s_mov_b32 m0, 64512
    s_add_u32 s36, s34, 368640
    buffer_load_dwordx4 v1, s[24:27], s36 offen nt lds
    s_mov_b32 m0, 65536
    s_add_u32 s36, s35, 0
    buffer_load_dwordx4 v2, s[8:11], s36 offen nt lds
    s_mov_b32 m0, 66560
    s_add_u32 s36, s35, 10240
    buffer_load_dwordx4 v2, s[8:11], s36 offen nt lds
    s_mov_b32 m0, 67584
    s_add_u32 s36, s35, 20480
    buffer_load_dwordx4 v2, s[8:11], s36 offen nt lds
    s_mov_b32 m0, 68608
    s_add_u32 s36, s35, 30720
    buffer_load_dwordx4 v2, s[8:11], s36 offen nt lds
    s_mov_b32 m0, 69632
    s_add_u32 s36, s35, 40960
    buffer_load_dwordx4 v2, s[8:11], s36 offen nt lds
    s_mov_b32 m0, 70656
    s_add_u32 s36, s35, 51200
    buffer_load_dwordx4 v2, s[8:11], s36 offen nt lds
    s_mov_b32 m0, 71680
    s_add_u32 s36, s35, 61440
    buffer_load_dwordx4 v2, s[8:11], s36 offen nt lds
    s_mov_b32 m0, 72704
    s_add_u32 s36, s35, 71680
    buffer_load_dwordx4 v2, s[8:11], s36 offen nt lds
L_T_nodma:
    v_mov_b32 v5, 20
    s_mov_b32 s95, 0
SP_47:
    ds_read_b32 v4, v5
    s_waitcnt lgkmcnt(0)
    v_readfirstlane_b32 s93, v4
    s_cmp_eq_u32 s93, 8
    s_cbranch_scc1 SPD_48
    s_sleep 1
    s_add_u32 s95, s95, 1
    s_cmp_lt_u32 s95, 0x40000
    s_cbranch_scc1 SP_47
SPD_48:
    s_mov_b32 s95, 0
L_T_pa:
    buffer_load_dword v4, v96, s[16:19], s82 offen offset:0 sc1
    buffer_load_dword v5, v96, s[16:19], s82 offen offset:768 sc1
    buffer_load_dword v6, v96, s[16:19], s82 offen offset:1536 sc1
    buffer_load_dword v7, v96, s[16:19], s82 offen offset:2304 sc1
    buffer_load_dword v8, v96, s[16:19], s82 offen offset:3072 sc1
    buffer_load_dword v9, v96, s[16:19], s82 offen offset:3840 sc1
    buffer_load_dword v10, v96, s[16:19], s83 offen offset:0 sc1
    buffer_load_dword v11, v96, s[16:19], s83 offen offset:768 sc1
    ds_read_b32 v12, v115
    s_waitcnt vmcnt(0) lgkmcnt(0)
    v_readfirstlane_b32 s93, v12
    v_max3_u32 v20, v4, v5, v6
    v_max3_u32 v20, v20, v7, v8
    v_max3_u32 v20, v20, v9, v10
    v_max_u32 v20, v20, v11
    v_cmp_eq_u32 vcc, -1, v20
    s_cbranch_vccz L_T_px
    s_cmp_eq_u32 s93, 1
    s_cbranch_scc1 L_T_py
    s_add_u32 s95, s95, 1
    s_cmp_lt_u32 s95, 0x10000
    s_cbranch_scc1 L_T_pa
L_T_px:

    v_pk_add_f32 v[4:5], v[4:5], v[6:7]
    v_pk_add_f32 v[8:9], v[8:9], v[10:11]
    v_pk_add_f32 v[4:5], v[4:5], v[8:9]
    v_add_f32 v4, v4, v5
    v_cvt_pk_bf16_f32 v4, v4, v4
    ds_write_b16 v97, v4 offset:14336
    s_waitcnt lgkmcnt(0)
    s_mov_b64 exec, 1
    ds_add_u32 v21, v22
    s_mov_b64 exec, -1

    v_mov_b32 v5, 32
    s_mov_b32 s95, 0
SP_49:
    ds_read_b32 v6, v5
    s_waitcnt lgkmcnt(0)
    v_readfirstlane_b32 s93, v6
    s_cmp_eq_u32 s93, 1
    s_cbranch_scc1 SPD_50
    s_add_u32 s95, s95, 1
    s_cmp_lt_u32 s95, 0x40000
    s_cbranch_scc1 SP_49
SPD_50:
    ds_read_b64_tr_b16 v[40:41], v114 offset:0
    ds_read_b64_tr_b16 v[42:43], v114 offset:512
    ds_read_b64_tr_b16 v[44:45], v114 offset:4096
    ds_read_b64_tr_b16 v[46:47], v114 offset:4608
    ds_read_b64_tr_b16 v[48:49], v114 offset:8192
    ds_read_b64_tr_b16 v[50:51], v114 offset:8704
    ds_read_b64_tr_b16 v[52:53], v114 offset:12288
    ds_read_b64_tr_b16 v[54:55], v114 offset:12800
    s_waitcnt lgkmcnt(0)
    ds_read_b64_tr_b16 v[56:57], v114 offset:16384
    ds_read_b64_tr_b16 v[58:59], v114 offset:16896
    ds_read_b64_tr_b16 v[60:61], v114 offset:20480
    ds_read_b64_tr_b16 v[62:63], v114 offset:20992
    ds_read_b64_tr_b16 v[64:65], v114 offset:24576
    ds_read_b64_tr_b16 v[66:67], v114 offset:25088
    ds_read_b64_tr_b16 v[68:69], v114 offset:28672
    ds_read_b64_tr_b16 v[70:71], v114 offset:29184
    s_branch L_T_pz
L_T_py:
    ds_read_b64_tr_b16 v[40:41], v114 offset:0
    ds_read_b64_tr_b16 v[42:43], v114 offset:512
    ds_read_b64_tr_b16 v[44:45], v114 offset:4096
    ds_read_b64_tr_b16 v[46:47], v114 offset:4608
    ds_read_b64_tr_b16 v[48:49], v114 offset:8192
    ds_read_b64_tr_b16 v[50:51], v114 offset:8704
    ds_read_b64_tr_b16 v[52:53], v114 offset:12288
    ds_read_b64_tr_b16 v[54:55], v114 offset:12800
    s_waitcnt lgkmcnt(0)
    ds_read_b64_tr_b16 v[56:57], v114 offset:16384
    ds_read_b64_tr_b16 v[58:59], v114 offset:16896
    ds_read_b64_tr_b16 v[60:61], v114 offset:20480
    ds_read_b64_tr_b16 v[62:63], v114 offset:20992
    ds_read_b64_tr_b16 v[64:65], v114 offset:24576
    ds_read_b64_tr_b16 v[66:67], v114 offset:25088
    ds_read_b64_tr_b16 v[68:69], v114 offset:28672
    ds_read_b64_tr_b16 v[70:71], v114 offset:29184
    s_mov_b32 s95, 0
PL_51:
    buffer_load_dword v4, v96, s[16:19], s82 offen offset:0 sc1
    buffer_load_dword v5, v96, s[16:19], s82 offen offset:768 sc1
    buffer_load_dword v6, v96, s[16:19], s82 offen offset:1536 sc1
    buffer_load_dword v7, v96, s[16:19], s82 offen offset:2304 sc1
    buffer_load_dword v8, v96, s[16:19], s82 offen offset:3072 sc1
    buffer_load_dword v9, v96, s[16:19], s82 offen offset:3840 sc1
    buffer_load_dword v10, v96, s[16:19], s83 offen offset:0 sc1
    buffer_load_dword v11, v96, s[16:19], s83 offen offset:768 sc1
    s_waitcnt vmcnt(0)
    v_max3_u32 v20, v4, v5, v6
    v_max3_u32 v20, v20, v7, v8
    v_max3_u32 v20, v20, v9, v10
    v_max_u32 v20, v20, v11
    v_cmp_eq_u32 vcc, -1, v20
    s_cbranch_vccz PD_52
    s_add_u32 s95, s95, 1
    s_cmp_lt_u32 s95, 0x10000
    s_cbranch_scc1 PL_51
PD_52:
    v_pk_add_f32 v[4:5], v[4:5], v[6:7]
    v_pk_add_f32 v[8:9], v[8:9], v[10:11]
    v_pk_add_f32 v[4:5], v[4:5], v[8:9]
    v_add_f32 v4, v4, v5
    v_cvt_pk_bf16_f32 v4, v4, v4
    ds_write_b16 v97, v4 offset:14336
    s_waitcnt lgkmcnt(0)
    s_mov_b64 exec, 1
    ds_add_u32 v21, v22
    s_mov_b64 exec, -1

L_T_pz:
    v_mov_b32 v5, 24
    s_mov_b32 s95, 0
SP_53:
    ds_read_b32 v6, v5
    s_waitcnt lgkmcnt(0)
    v_readfirstlane_b32 s93, v6
    s_cmp_eq_u32 s93, 4
    s_cbranch_scc1 SPD_54
    s_add_u32 s95, s95, 1
    s_cmp_lt_u32 s95, 0x40000
    s_cbranch_scc1 SP_53
SPD_54:
    ds_read_b128 v[116:119], v98 offset:14336
    ds_read_b128 v[120:123], v98 offset:14400
    ds_read_b128 v[124:127], v98 offset:14464
    ds_read_b128 v[128:131], v98 offset:14528
    ds_read_b128 v[132:135], v98 offset:14592
    ds_read_b128 v[136:139], v98 offset:14656
    ds_read_b128 v[140:143], v98 offset:14720
    ds_read_b128 v[144:147], v98 offset:14784
    s_waitcnt lgkmcnt(7)
    v_mfma_f32_16x16x32_bf16 v[4:7], v[116:119], v[40:43], 0
    s_waitcnt lgkmcnt(6)
    v_mfma_f32_16x16x32_bf16 v[4:7], v[120:123], v[44:47], v[4:7]
    s_waitcnt lgkmcnt(5)
    v_mfma_f32_16x16x32_bf16 v[4:7], v[124:127], v[48:51], v[4:7]
    s_waitcnt lgkmcnt(4)
    v_mfma_f32_16x16x32_bf16 v[4:7], v[128:131], v[52:55], v[4:7]
    s_waitcnt lgkmcnt(3)
    v_mfma_f32_16x16x32_bf16 v[4:7], v[132:135], v[56:59], v[4:7]
    s_waitcnt lgkmcnt(2)
    v_mfma_f32_16x16x32_bf16 v[4:7], v[136:139], v[60:63], v[4:7]
    s_waitcnt lgkmcnt(1)
    v_mfma_f32_16x16x32_bf16 v[4:7], v[140:143], v[64:67], v[4:7]
    s_waitcnt lgkmcnt(0)
    v_mfma_f32_16x16x32_bf16 v[4:7], v[144:147], v[68:71], v[4:7]
    s_nop 7
    v_min_u32 v4, -2, v4
    buffer_store_dword v4, v104, s[16:19], s84 offen sc0 sc1
    buffer_store_dword v4, v104, s[16:19], s53 offen sc0 sc1
    ds_read_b64_tr_b16 v[72:73], v107 offset:0
    ds_read_b64_tr_b16 v[74:75], v107 offset:512
    ds_read_b64_tr_b16 v[76:77], v107 offset:4096
    ds_read_b64_tr_b16 v[78:79], v107 offset:4608
    ds_read_b64_tr_b16 v[80:81], v107 offset:8192
    ds_read_b64_tr_b16 v[82:83], v107 offset:8704
    ds_read_b64_tr_b16 v[84:85], v107 offset:12288
    ds_read_b64_tr_b16 v[86:87], v107 offset:12800
    ds_read_b64_tr_b16 v[88:89], v107 offset:16384
    ds_read_b64_tr_b16 v[90:91], v107 offset:16896
    ds_read_b64_tr_b16 v[92:93], v107 offset:20480
    ds_read_b64_tr_b16 v[94:95], v107 offset:20992
    s_cmp_eq_u32 s58, 0
    s_cbranch_scc1 L_T_h2c
    s_mov_b32 s95, 0
PL_55:
    buffer_load_dwordx4 v[4:7], v37, s[16:19], s52 offen offset:0 sc1
    buffer_load_dwordx4 v[8:11], v37, s[16:19], s52 offen offset:256 sc1
    buffer_load_dwordx4 v[12:15], v37, s[16:19], s52 offen offset:512 sc1
    s_waitcnt vmcnt(0)
    v_max3_u32 v20, v4, v5, v6
    v_max3_u32 v20, v20, v7, v8
    v_max3_u32 v20, v20, v9, v10
    v_max3_u32 v20, v20, v11, v12
    v_max3_u32 v20, v20, v13, v14
    v_max_u32 v20, v20, v15
    v_cmp_eq_u32 vcc, -1, v20
    s_cbranch_vccz PD_56
    s_add_u32 s95, s95, 1
    s_cmp_lt_u32 s95, 0x10000
    s_cbranch_scc1 PL_55
PD_56:
    v_pk_add_f32 v[4:5], v[4:5], v[8:9]
    v_pk_add_f32 v[6:7], v[6:7], v[10:11]
    v_pk_add_f32 v[4:5], v[4:5], v[12:13]
    v_pk_add_f32 v[6:7], v[6:7], v[14:15]

    s_nop 1
    v_permlane32_swap_b32 v4, v5
    v_permlane32_swap_b32 v6, v7
    v_add_f32 v4, v4, v5
    v_add_f32 v6, v6, v7
    s_nop 1
    v_permlane16_swap_b32 v4, v6
    v_add_f32 v4, v4, v6
    s_nop 1
    v_add_f32_dpp v4, v4, v4 row_ror:8 row_mask:0xf bank_mask:0xf

    v_cvt_pk_bf16_f32 v4, v4, v4
    v_and_b32 v4, 0xffff0000, v4
    v_mul_f32 v4, v31, v4
    v_cvt_pk_bf16_f32 v4, v4, v4
    v_and_b32 v4, 0xffff0000, v4
    v_add_f32 v4, v30, v4
    v_cvt_pk_bf16_f32 v32, v4, v4
    v_and_b32 v32, 0xffff0000, v32
    s_cmp_eq_u32 s45, 1
    s_cbranch_scc0 SF_57
    buffer_store_dword v32, v38, s[16:19], s51 offen
SJ_58:
L_T_h2c:
    s_mov_b32 s95, 0
PL_59:
    buffer_load_dwordx4 v[4:7], v105, s[16:19], s86 offen sc1
    buffer_load_dwordx4 v[8:11], v105, s[16:19], s86 offen offset:1024 sc1
    buffer_load_dwordx2 v[12:13], v106, s[16:19], s86 offen offset:2048 sc1
    buffer_load_dwordx2 v[14:15], v106, s[16:19], s87 offen sc1
    s_waitcnt vmcnt(0)
    v_max3_u32 v20, v4, v5, v6
    v_max3_u32 v20, v20, v7, v8
    v_max3_u32 v20, v20, v9, v10
    v_max3_u32 v20, v20, v11, v12
    v_max3_u32 v20, v20, v13, v14
    v_max_u32 v20, v20, v15
    v_cmp_eq_u32 vcc, -1, v20
    s_cbranch_vccz PD_60
    s_add_u32 s95, s95, 1
    s_cmp_lt_u32 s95, 0x10000
    s_cbranch_scc1 PL_59
PD_60:
    v_readfirstlane_b32 s20, v4
    s_nop 1
    v_subrev_f32 v4, s20, v4
    v_subrev_f32 v5, s20, v5
    v_subrev_f32 v6, s20, v6
    v_subrev_f32 v7, s20, v7
    v_subrev_f32 v8, s20, v8
    v_subrev_f32 v9, s20, v9
    v_subrev_f32 v10, s20, v10
    v_subrev_f32 v11, s20, v11
    v_subrev_f32 v12, s20, v12
    v_subrev_f32 v13, s20, v13
    v_pk_mul_f32 v[16:17], v[4:5], v[4:5]
    v_pk_add_f32 v[18:19], v[4:5], v[6:7]
    v_pk_fma_f32 v[16:17], v[6:7], v[6:7], v[16:17]
    v_pk_add_f32 v[18:19], v[18:19], v[8:9]
    v_pk_fma_f32 v[16:17], v[8:9], v[8:9], v[16:17]
    v_pk_add_f32 v[18:19], v[18:19], v[10:11]
    v_pk_fma_f32 v[16:17], v[10:11], v[10:11], v[16:17]
    v_pk_add_f32 v[18:19], v[18:19], v[12:13]
    v_pk_fma_f32 v[16:17], v[12:13], v[12:13], v[16:17]
    v_add_f32 v18, v18, v19
    v_add_f32 v16, v16, v17
    s_nop 1
    v_permlane32_swap_b32 v18, v16
    v_add_f32 v18, v18, v16

    s_nop 1
    v_add_f32_dpp v18, v18, v18 row_ror:8 row_mask:0xf bank_mask:0xf
    s_nop 1
    v_add_f32_dpp v18, v18, v18 row_ror:4 row_mask:0xf bank_mask:0xf
    s_nop 1
    v_add_f32_dpp v18, v18, v18 row_ror:2 row_mask:0xf bank_mask:0xf
    s_nop 1
    v_add_f32_dpp v18, v18, v18 row_ror:1 row_mask:0xf bank_mask:0xf
    v_mov_b32 v16, v18
    s_nop 1
    v_permlane16_swap_b32 v18, v16
    v_add_f32 v18, v18, v16
    v_mul_f32 v18, 0x3acccccd, v18
    s_nop 0
    v_readlane_b32 s21, v18, 0
    v_readlane_b32 s22, v18, 32
    s_nop 1
    v_mov_b32 v16, s21
    v_mov_b32 v17, s22
    v_fma_f32 v17, -v16, v16, v17
    v_max_f32 v17, 0, v17
    v_add_f32 v16, s20, v16

    v_cvt_pk_bf16_f32 v17, v17, v17
    v_and_b32 v17, 0xffff0000, v17
    v_add_f32 v17, 0x3727c5ac, v17
    v_cvt_pk_bf16_f32 v17, v17, v17
    v_and_b32 v17, 0xffff0000, v17
    v_sqrt_f32 v17, v17
    v_cvt_pk_bf16_f32 v16, v16, v16
    v_and_b32 v16, 0xffff0000, v16
    v_cvt_pk_bf16_f32 v17, v17, v17
    v_and_b32 v17, 0xffff0000, v17
    v_rcp_f32 v18, v17
    v_sub_f32 v14, v14, v16
    v_sub_f32 v15, v15, v16
    v_cvt_pk_bf16_f32 v19, v14, v15
    v_lshlrev_b32 v14, 16, v19
    v_and_b32 v15, 0xffff0000, v19
    v_mul_f32 v4, v14, v18
    v_mul_f32 v5, v15, v18
    v_fma_f32 v6, -v4, v17, v14
    v_fma_f32 v7, -v5, v17, v15
    v_fma_f32 v14, v6, v18, v4
    v_fma_f32 v15, v7, v18, v5
    v_cvt_pk_bf16_f32 v19, v14, v15
    v_lshlrev_b32 v14, 16, v19
    v_and_b32 v15, 0xffff0000, v19
    v_mul_f32 v14, v14, v110
    v_mul_f32 v15, v15, v112
    v_cvt_pk_bf16_f32 v19, v14, v15
    v_lshlrev_b32 v14, 16, v19
    v_and_b32 v15, 0xffff0000, v19
    v_add_f32 v14, v14, v111
    v_add_f32 v15, v15, v113
    v_cvt_pk_bf16_f32 v19, v14, v15
    ds_write_b32 v101, v19 offset:14848
    s_waitcnt lgkmcnt(0)

    ds_read_b128 v[116:119], v99 offset:14848
    ds_read_b128 v[120:123], v99 offset:14912
    ds_read_b128 v[124:127], v99 offset:14976
    ds_read_b128 v[128:131], v99 offset:15040
    s_waitcnt lgkmcnt(3)
    v_mfma_f32_16x16x32_bf16 v[4:7], v[116:119], v[72:75], 0
    s_waitcnt lgkmcnt(2)
    v_mfma_f32_16x16x32_bf16 v[4:7], v[120:123], v[76:79], v[4:7]
    s_waitcnt lgkmcnt(1)
    v_mfma_f32_16x16x32_bf16 v[4:7], v[124:127], v[80:83], v[4:7]
    s_waitcnt lgkmcnt(0)
    v_mfma_f32_16x16x32_bf16 v[4:7], v[128:131], v[84:87], v[4:7]
    s_nop 7
    v_min_u32 v4, -2, v4
    s_cmp_eq_u32 s45, 1
    s_cbranch_scc0 SF_61
    buffer_store_dword v4, v104, s[16:19], s48 offen
SJ_62:
    s_mov_b32 s95, 0
PL_63:
    buffer_load_dword v8, v103, s[16:19], s49 offen offset:0 sc1
    buffer_load_dword v9, v103, s[16:19], s50 offen offset:0 sc1
    buffer_load_dword v10, v103, s[16:19], s49 offen offset:768 sc1
    buffer_load_dword v11, v103, s[16:19], s50 offen offset:768 sc1
    buffer_load_dword v12, v103, s[16:19], s49 offen offset:1536 sc1
    buffer_load_dword v13, v103, s[16:19], s50 offen offset:1536 sc1
    buffer_load_dword v14, v103, s[16:19], s49 offen offset:2304 sc1
    buffer_load_dword v15, v103, s[16:19], s50 offen offset:2304 sc1
    buffer_load_dword v16, v103, s[16:19], s49 offen offset:3072 sc1
    buffer_load_dword v17, v103, s[16:19], s50 offen offset:3072 sc1
    s_waitcnt vmcnt(0)
    v_max3_u32 v20, v8, v9, v10
    v_max3_u32 v20, v20, v11, v12
    v_max3_u32 v20, v20, v13, v14
    v_max3_u32 v20, v20, v15, v16
    v_max_u32 v20, v20, v17
    v_cmp_eq_u32 vcc, -1, v20
    s_cbranch_vccz PD_64
    s_add_u32 s95, s95, 1
    s_cmp_lt_u32 s95, 0x10000
    s_cbranch_scc1 PL_63
PD_64:
    v_pk_add_f32 v[8:9], v[8:9], v[10:11]
    v_pk_add_f32 v[12:13], v[12:13], v[14:15]
    v_pk_add_f32 v[8:9], v[8:9], v[16:17]
    v_pk_add_f32 v[8:9], v[8:9], v[12:13]
    v_cvt_pk_bf16_f32 v10, v8, v9
    v_lshlrev_b32 v8, 16, v10
    v_and_b32 v9, 0xffff0000, v10
    v_mul_f32 v8, v8, v9
    v_cvt_pk_bf16_f32 v8, v8, v8
    ds_write_b16 v102, v8 offset:15872
    s_waitcnt lgkmcnt(0)

    ds_read_b128 v[116:119], v100 offset:15872
    ds_read_b128 v[120:123], v100 offset:15936
    s_waitcnt lgkmcnt(1)
    v_mfma_f32_16x16x32_bf16 v[4:7], v[116:119], v[88:91], 0
    s_waitcnt lgkmcnt(0)
    v_mfma_f32_16x16x32_bf16 v[4:7], v[120:123], v[92:95], v[4:7]
    s_nop 7
    v_min_u32 v4, -2, v4
    buffer_store_dword v4, v104, s[16:19], s85 offen sc0 sc1
    buffer_store_dword v4, v104, s[16:19], s54 offen sc0 sc1
    s_cmp_eq_u32 s59, 0
    s_cbranch_scc1 L_T_end
    s_mov_b32 s95, 0
PL_65:
    buffer_load_dwordx4 v[4:7], v37, s[16:19], s55 offen offset:0 sc1
    buffer_load_dwordx4 v[8:11], v37, s[16:19], s55 offen offset:256 sc1
    buffer_load_dwordx4 v[12:15], v37, s[16:19], s55 offen offset:512 sc1
    s_waitcnt vmcnt(0)
    v_max3_u32 v20, v4, v5, v6
    v_max3_u32 v20, v20, v7, v8
    v_max3_u32 v20, v20, v9, v10
    v_max3_u32 v20, v20, v11, v12
    v_max3_u32 v20, v20, v13, v14
    v_max_u32 v20, v20, v15
    v_cmp_eq_u32 vcc, -1, v20
    s_cbranch_vccz PD_66
    s_add_u32 s95, s95, 1
    s_cmp_lt_u32 s95, 0x10000
    s_cbranch_scc1 PL_65
PD_66:
    v_pk_add_f32 v[4:5], v[4:5], v[8:9]
    v_pk_add_f32 v[6:7], v[6:7], v[10:11]
    v_pk_add_f32 v[4:5], v[4:5], v[12:13]
    v_pk_add_f32 v[6:7], v[6:7], v[14:15]

    s_nop 1
    v_permlane32_swap_b32 v4, v5
    v_permlane32_swap_b32 v6, v7
    v_add_f32 v4, v4, v5
    v_add_f32 v6, v6, v7
    s_nop 1
    v_permlane16_swap_b32 v4, v6
    v_add_f32 v4, v4, v6
    s_nop 1
    v_add_f32_dpp v4, v4, v4 row_ror:8 row_mask:0xf bank_mask:0xf

    v_cvt_pk_bf16_f32 v4, v4, v4
    v_and_b32 v4, 0xffff0000, v4
    v_mul_f32 v4, v34, v4
    v_cvt_pk_bf16_f32 v4, v4, v4
    v_and_b32 v4, 0xffff0000, v4
    v_add_f32 v4, v32, v4
    v_cvt_pk_bf16_f32 v4, v4, v4
    buffer_store_short v4, v39, s[28:31], s60 offen
L_T_end:
L_end:
    s_endpgm
SF_13:
    buffer_store_dwordx4 v[28:31], v1, s[16:19], s21 offen sc1
    s_branch SJ_14
SF_25:
    buffer_store_dwordx4 v[4:7], v36, s[16:19], s21 offen sc1
    s_branch SJ_26
SF_39:
    buffer_store_dword v33, v38, s[16:19], s21 offen sc1
    s_branch SJ_40
SF_57:
    buffer_store_dword v32, v38, s[16:19], s51 offen sc1
    s_branch SJ_58
SF_61:
    buffer_store_dword v4, v104, s[16:19], s48 offen sc1
    s_branch SJ_62
.section .rodata,"a"
.p2align 6
.amdhsa_kernel adaLN_cond__gqa_block_cached__glu_gated_bilinear__decode_kernel
  .amdhsa_next_free_vgpr 168
  .amdhsa_next_free_sgpr 102
  .amdhsa_accum_offset 168
  .amdhsa_group_segment_fixed_size 0
  .amdhsa_kernarg_size 112
  .amdhsa_user_sgpr_count 2
  .amdhsa_user_sgpr_kernarg_segment_ptr 1
  .amdhsa_system_sgpr_workgroup_id_x 1
  .amdhsa_float_denorm_mode_32 3
.end_amdhsa_kernel
```
